```python
import torch

def _softmax(x, axis=-1):
    return torch.softmax(x, dim=axis)
def _gelu(x):
    return torch.nn.functional.gelu(x, approximate="tanh")
def _silu(x):
    return torch.nn.functional.silu(x)
def _sigmoid(x):
    return torch.sigmoid(x)
def _layernorm(x, axis=-1, eps=1e-5):
    m = x.mean(dim=axis, keepdim=True)
    v = x.var(dim=axis, keepdim=True, unbiased=False)
    return (x - m) / torch.sqrt(v + eps)
def _scatter_add(tgt, idx, src, axis=0):
    return tgt.clone().index_add_(axis, idx, src)
def _segment_sum(src, seg, n):
    out = torch.zeros((n,) + src.shape[1:], dtype=src.dtype)
    return out.index_add_(0, seg, src)
def _pad(x, pw):
    flat = tuple(v for pair in reversed(pw) for v in pair)
    return torch.nn.functional.pad(x, flat)

kernel_name = 'interleave_layers__gqa_block_cached__gqa_block_cached__decode'

def setup_inputs():

    _w = (lambda a: (lambda t: t.to(torch.bfloat16) if t.is_floating_point() else t)(torch.as_tensor(a)))
    def _A_setup():
        B, Sq, D = 4, 1, 640
        Hq, Hkv, Sk, Dh = 32, 32, 4096, 128
        assert Hq % Hkv == 0, (Hq, Hkv)
        return {
            "x": _w((lambda *s: torch.randn(*s, dtype=torch.bfloat16) * 0.1)(B, Sq, D)),
            "k_cache": _w((lambda *s: torch.randn(*s, dtype=torch.bfloat16) * 0.8)(B, Hkv, Sk, Dh)),
            "v_cache": _w((lambda *s: torch.randn(*s, dtype=torch.bfloat16) * 3.2)(B, Hkv, Sk, Dh)),
            "wq": _w((lambda *s: torch.randn(*s, dtype=torch.bfloat16) * 0.8)(D, Hq * Dh) * (D ** -0.5)),
            "wo": _w((lambda *s: torch.randn(*s, dtype=torch.bfloat16) * 3.2)(Hq * Dh, D) * ((Hq * Dh) ** -0.5)),
        }
    _A_in = _A_setup()

    def _B_setup():
        B, Sq, D = 4, 1, 640
        Hq, Hkv, Sk, Dh = 32, 32, 4096, 128
        assert Hq % Hkv == 0, (Hq, Hkv)
        return {
            "x": _w((lambda *s: torch.randn(*s, dtype=torch.bfloat16) * 0.1)(B, Sq, D)),
            "k_cache": _w((lambda *s: torch.randn(*s, dtype=torch.bfloat16) * 1.6)(B, Hkv, Sk, Dh)),
            "v_cache": _w((lambda *s: torch.randn(*s, dtype=torch.bfloat16) * 1.6)(B, Hkv, Sk, Dh)),
            "wq": _w((lambda *s: torch.randn(*s, dtype=torch.bfloat16) * 1.6)(D, Hq * Dh) * (D ** -0.5)),
            "wo": _w((lambda *s: torch.randn(*s, dtype=torch.bfloat16) * 1.6)(Hq * Dh, D) * ((Hq * Dh) ** -0.5)),
        }
    _B_in = _B_setup()

    return {
        "A_x": _A_in["x"],
        "A_k_cache": _A_in["k_cache"],
        "A_v_cache": _A_in["v_cache"],
        "A_wq": _A_in["wq"],
        "A_wo": _A_in["wo"],
        "B_x": _B_in["x"],
        "B_k_cache": _B_in["k_cache"],
        "B_v_cache": _B_in["v_cache"],
        "B_wq": _B_in["wq"],
        "B_wo": _B_in["wo"],
    }

def reference(A_x, A_k_cache, A_v_cache, A_wq, A_wo, B_x, B_k_cache, B_v_cache, B_wq, B_wo):
    def _A_ref(x, k_cache, v_cache, wq, wo):
        B, Sq, D = x.shape
        Hq, Dh = 32, 128
        Hkv = k_cache.shape[1]
        rep = Hq // Hkv
        q = (lambda x, *d: x.permute(*d))((x @ wq).reshape(B, Sq, Hq, Dh), 0, 2, 1, 3)
        k = (lambda x, n, axis: torch.repeat_interleave(x, n, dim=axis))(k_cache, rep, axis=1)
        v = (lambda x, n, axis: torch.repeat_interleave(x, n, dim=axis))(v_cache, rep, axis=1)
        scores = torch.einsum("bhqd,bhkd->bhqk", q, k) * (Dh ** -0.5)
        p = _softmax(scores, axis=-1)
        o = torch.einsum("bhqk,bhkd->bhqd", p, v)
        return (lambda x, *d: x.permute(*d))(o, 0, 2, 1, 3).reshape(B, Sq, Hq * Dh) @ wo

    def _B_ref(x, k_cache, v_cache, wq, wo):
        B, Sq, D = x.shape
        Hq, Dh = 32, 128
        Hkv = k_cache.shape[1]
        rep = Hq // Hkv
        q = (lambda x, *d: x.permute(*d))((x @ wq).reshape(B, Sq, Hq, Dh), 0, 2, 1, 3)
        k = (lambda x, n, axis: torch.repeat_interleave(x, n, dim=axis))(k_cache, rep, axis=1)
        v = (lambda x, n, axis: torch.repeat_interleave(x, n, dim=axis))(v_cache, rep, axis=1)
        scores = torch.einsum("bhqd,bhkd->bhqk", q, k) * (Dh ** -0.5)
        p = _softmax(scores, axis=-1)
        o = torch.einsum("bhqk,bhkd->bhqd", p, v)
        return (lambda x, *d: x.permute(*d))(o, 0, 2, 1, 3).reshape(B, Sq, Hq * Dh) @ wo

    x = A_x
    x = x + _A_ref(_layernorm(x, axis=-1), A_k_cache, A_v_cache, A_wq, A_wo)
    x = x + _B_ref(_layernorm(x, axis=-1), B_k_cache, B_v_cache, B_wq, B_wo)
    x = x + _A_ref(_layernorm(x, axis=-1), A_k_cache, A_v_cache, A_wq, A_wo)
    x = x + _B_ref(_layernorm(x, axis=-1), B_k_cache, B_v_cache, B_wq, B_wo)
    return x
```

```asm
; @launch grid=(256,1,1) block=(256,1,1) lds=163840
.amdgcn_target "amdgcn-amd-amdhsa--gfx950"
.text
.globl interleave_layers__gqa_block_cached__gqa_block_cached__decode_kernel
.p2align 8
.type interleave_layers__gqa_block_cached__gqa_block_cached__decode_kernel,@function
interleave_layers__gqa_block_cached__gqa_block_cached__decode_kernel:
    s_cmp_ge_u32 s2, 256
    s_cbranch_scc1 L_END
    s_load_dwordx16 s[16:31], s[0:1], 0
    s_load_dwordx8 s[32:39], s[0:1], 64
    s_load_dwordx2 s[40:41], s[0:1], 96
    v_lshrrev_b32_e64 v1, 6, v0
    v_and_b32 v47, 63, v0
    v_readfirstlane_b32 s5, v1
    s_getreg_b32 s6, hwreg(HW_REG_XCC_ID, 0, 4)
    s_cmp_lt_u32 s6, 8
    s_cselect_b32 s99, 1, 0x10001
    s_and_b32 s6, s6, 7
    v_mov_b32 v2, 0
    s_getpc_b64 s[88:89]
L_PC:
    s_sub_u32 s88, s88, L_PC-interleave_layers__gqa_block_cached__gqa_block_cached__decode_kernel
    s_subb_u32 s89, s89, 0
    s_and_b32 s89, s89, 0xffff
    s_mov_b32 s90, L_END-interleave_layers__gqa_block_cached__gqa_block_cached__decode_kernel
    s_mov_b32 s91, 0x20000
    s_lshr_b32 s10, s2, 3
    s_lshl_b32 s8, s10, 12
    v_lshl_add_u32 v42, v0, 4, s8
    buffer_load_dwordx4 v[60:63], v42, s[88:91], 0 offen
    v_lshlrev_b32 v43, 4, v47
    s_lshl_b32 s10, s10, 2
    s_add_u32 s10, s10, s5
    s_lshl_b32 s10, s10, 13
    s_lshl_b32 s8, s6, 10
    s_add_u32 s10, s10, s8
    s_mov_b32 s7, 8
    s_waitcnt lgkmcnt(0)
    s_mov_b32 s84, s38
    s_and_b32 s85, s39, 0xffff
    s_mov_b32 s86, 256
    s_mov_b32 s87, 0x20000
    s_cmp_lg_u32 s5, 0
    s_cbranch_scc1 L_TKW
    s_mov_b64 exec, 1
L_TK:
    s_lshl_b32 s8, s6, 5
    v_mov_b32_e64 v3, 1
    buffer_atomic_add v3, v2, s[84:87], s8 offen sc0 sc1
    s_waitcnt vmcnt(0)
    v_readfirstlane_b32 s9, v3
    s_nop 0
    s_cmp_lt_u32 s9, 32
    s_nop 1
    s_cbranch_scc1 L_TKD
    s_mov_b32 s99, 0x10001
    s_add_u32 s6, s6, 1
    s_and_b32 s6, s6, 7
    s_sub_u32 s7, s7, 1
    s_cmp_lg_u32 s7, 0
    s_cbranch_scc1 L_TK
    s_and_b32 s6, s2, 7
    s_lshr_b32 s9, s2, 3
L_TKD:
    s_lshl_b32 s6, s6, 5
    s_or_b32 s6, s6, s9
    v_mov_b32_e64 v3, s6
    ds_write_b32 v2, v3 offset:8184
    s_mov_b64 exec, -1
    s_waitcnt lgkmcnt(0)
L_TKW:
    s_mov_b32 s88, s22
    s_and_b32 s89, s23, 0xffff
    s_mov_b32 s90, 0x500000
    s_mov_b32 s91, 0x20000
    buffer_load_dwordx4 v[60:63], v43, s[88:91], s10 offen
    s_add_u32 s10, s10, 1048576
    buffer_load_dwordx4 v[60:63], v43, s[88:91], s10 offen
    s_add_u32 s10, s10, 1048576
    buffer_load_dwordx4 v[60:63], v43, s[88:91], s10 offen
    s_add_u32 s10, s10, 1048576
    buffer_load_dwordx4 v[60:63], v43, s[88:91], s10 offen
    s_add_u32 s10, s10, 1048576
    buffer_load_dwordx4 v[60:63], v43, s[88:91], s10 offen
    s_mov_b32 s62, 200000
    s_mov_b32 s98, 0
    s_mov_b32 s79, 0
    v_and_b32_e64 v46, 15, v47
    v_lshrrev_b32 v45, 4, v47
    s_barrier
    ds_read_b32 v3, v2 offset:8184
    s_waitcnt lgkmcnt(0)
    v_readfirstlane_b32 s6, v3
    v_nop_e64
    s_and_b32 s6, s6, 255
    s_and_b32 s7, s6, 31
    v_mov_b32 v0, 0
    s_lshr_b32 s3, s6, 5
    s_lshl_b32 s3, s3, 2
    s_and_b32 s8, s7, 3
    s_add_u32 s3, s3, s8
    s_lshr_b32 s4, s7, 2
    s_add_u32 s4, s4, 7
    s_and_b32 s4, s4, 7
    s_cmp_eq_u32 s4, 7
    s_cbranch_scc1 L_COMM
    s_mul_i32 s12, s5, 7
    s_add_u32 s12, s12, s4
    s_and_b32 s15, s3, 3
    s_mul_i32 s15, s15, 28
    s_add_u32 s15, s15, s12
    s_lshr_b32 s42, s3, 2
    s_mul_i32 s43, s42, 655360
    s_lshl_b32 s42, s42, 10
    s_waitcnt lgkmcnt(0)
    s_mov_b32 s80, s40
    s_and_b32 s81, s41, 0xffff
    s_mov_b32 s82, 0xd00000
    s_mov_b32 s83, 0x20000
    s_mov_b32 s84, s38
    s_nop 0
    s_and_b32 s85, s39, 0xffff
    s_mov_b32 s86, 256
    s_mov_b32 s87, 0x20000
    s_mov_b32 s63, 0x3e0293ee
    s_mov_b32 s70, 0x000f000f
    s_mov_b32 s71, 0x000f000f
    s_mov_b32 s72, 0x00f000f0
    s_mov_b32 s73, 0x00f000f0
    s_mov_b32 s74, 0x0f000f00
    s_mov_b32 s75, 0x0f000f00
    s_mov_b32 s76, 0xf000f000
    s_mov_b32 s77, 0xf000f000
    s_cmp_lt_u32 s12, 16
    s_cselect_b32 s9, 1, 0
    s_min_u32 s13, s12, 16
    s_mul_i32 s14, s12, 36
    s_add_u32 s13, s13, s14
    s_lshl_b32 s13, s13, 10
    s_lshl_b32 s14, s3, 20
    s_add_u32 s13, s13, s14
    s_mul_i32 s66, s5, 37888
    s_add_u32 s66, s66, 8192
    s_sub_u32 s60, 0x8000000, s13
    s_add_u32 s61, s60, s66
    s_add_u32 s44, s18, s13
    s_addc_u32 s45, s19, 0
    s_and_b32 s45, s45, 0xffff
    s_mov_b32 s46, s60
    s_mov_b32 s47, 0x20000
    s_add_u32 s48, s20, s13
    s_addc_u32 s49, s21, 0
    s_sub_u32 s48, s48, s66
    s_subb_u32 s49, s49, 0
    s_and_b32 s49, s49, 0xffff
    s_mov_b32 s50, s61
    s_mov_b32 s51, 0x20000
    s_add_u32 s52, s28, s13
    s_addc_u32 s53, s29, 0
    s_and_b32 s53, s53, 0xffff
    s_mov_b32 s54, s60
    s_mov_b32 s55, 0x20000
    s_add_u32 s56, s30, s13
    s_addc_u32 s57, s31, 0
    s_sub_u32 s56, s56, s66
    s_subb_u32 s57, s57, 0
    s_and_b32 s57, s57, 0xffff
    s_mov_b32 s58, s61
    s_mov_b32 s59, 0x20000
    v_and_b32 v44, 3, v47
    v_lshlrev_b32_e64 v19, 4, v44
    v_lshl_add_u32 v19, v45, 6, v19
    v_bfe_u32 v44, v47, 2, 2
    v_lshl_add_u32 v1, v44, 8, v19
    v_lshl_add_u32 v19, v45, 6, v19
    v_add_u32 v2, s66, v43
    s_lshl_b32 s10, s3, 9
    s_add_u32 s10, s10, 167936
    s_mul_i32 s11, s3, 4608
    s_mov_b32 s6, 0
    s_mov_b32 s7, 0
    s_lshl_b32 s14, s4, 9
    s_lshl_b32 s68, s4, 7
    s_add_u32 s68, s68, 3584
    s_lshl_b32 s13, s5, 3
    s_cmp_lg_u32 s5, 0
    s_cbranch_scc1 L_NOCLR
    v_add_u32 v40, s14, v43
    v_subrev_u32 v41, 512, v43
    v_add_u32 v41, s68, v41
    v_cmp_gt_u32 vcc, 32, v47
    s_nop 1
    v_cndmask_b32 v40, v41, v40, vcc
    v_mov_b32 v32, -1
    v_mov_b32 v33, -1
    v_mov_b32 v34, -1
    v_mov_b32 v35, -1
    v_mov_b32 v41, 0
    v_mov_b32 v36, 0
    v_mov_b32_e64 v37, 0
    ds_write_b64 v41, v[36:37]
    s_mov_b32 exec_hi, 0xff
    s_add_u32 s65, s11, 0
    s_nop 0
    buffer_store_dwordx4 v[32:35], v40, s[80:83], s65 offen sc1
    s_add_u32 s65, s11, 185344
    buffer_store_dwordx4 v[32:35], v40, s[80:83], s65 offen sc1
    s_add_u32 s65, s11, 370688
    buffer_store_dwordx4 v[32:35], v40, s[80:83], s65 offen sc1
    s_add_u32 s65, s11, 556032
    buffer_store_dwordx4 v[32:35], v40, s[80:83], s65 offen sc1
    s_add_u32 s65, s11, 741376
    buffer_store_dwordx4 v[32:35], v40, s[80:83], s65 offen sc1
    s_add_u32 s65, s11, 926720
    buffer_store_dwordx4 v[32:35], v40, s[80:83], s65 offen sc1
    s_add_u32 s65, s11, 1112064
    buffer_store_dwordx4 v[32:35], v40, s[80:83], s65 offen sc1
    s_add_u32 s65, s11, 1297408
    buffer_store_dwordx4 v[32:35], v40, s[80:83], s65 offen sc1
    s_add_u32 s65, s11, 1482752
    buffer_store_dwordx4 v[32:35], v40, s[80:83], s65 offen sc1
    s_add_u32 s65, s11, 1668096
    buffer_store_dwordx4 v[32:35], v40, s[80:83], s65 offen sc1
    s_add_u32 s65, s11, 1853440
    buffer_store_dwordx4 v[32:35], v40, s[80:83], s65 offen sc1
    s_add_u32 s65, s11, 2038784
    buffer_store_dwordx4 v[32:35], v40, s[80:83], s65 offen sc1
    s_add_u32 s65, s11, 2224128
    buffer_store_dwordx4 v[32:35], v40, s[80:83], s65 offen sc1
    s_add_u32 s65, s11, 2409472
    buffer_store_dwordx4 v[32:35], v40, s[80:83], s65 offen sc1
    s_add_u32 s65, s11, 2594816
    buffer_store_dwordx4 v[32:35], v40, s[80:83], s65 offen sc1
    s_add_u32 s65, s11, 2780160
    buffer_store_dwordx4 v[32:35], v40, s[80:83], s65 offen sc1
    s_mov_b64 exec, -1
    s_waitcnt lgkmcnt(0)
L_NOCLR:
    s_barrier
    s_mov_b32 s88, s24
    s_and_b32 s89, s25, 0xffff
    s_mov_b32 s90, 0x500000
    s_mov_b32 s91, 0x20000
    s_add_u32 s65, s15, 0
    s_min_u32 s65, s65, 319
    s_mul_hi_u32 s64, s65, 0x6666667
    s_mul_i32 s64, s64, 40
    s_add_u32 s65, s65, s64
    s_add_u32 s65, s65, 40
    s_lshl_b32 s65, s65, 10
    s_add_u32 s65, s65, s43
    buffer_load_dwordx4 v[48:51], v43, s[88:91], s65 offen offset:0
    s_waitcnt vmcnt(5)
    s_add_u32 s65, s15, 112
    s_min_u32 s65, s65, 319
    s_mul_hi_u32 s64, s65, 0x6666667
    s_mul_i32 s64, s64, 40
    s_add_u32 s65, s65, s64
    s_add_u32 s65, s65, 40
    s_lshl_b32 s65, s65, 10
    s_add_u32 s65, s65, s43
    buffer_load_dwordx4 v[48:51], v43, s[88:91], s65 offen offset:0
    s_waitcnt vmcnt(5)
    s_add_u32 s65, s15, 224
    s_min_u32 s65, s65, 319
    s_mul_hi_u32 s64, s65, 0x6666667
    s_mul_i32 s64, s64, 40
    s_add_u32 s65, s65, s64
    s_add_u32 s65, s65, 40
    s_lshl_b32 s65, s65, 10
    s_add_u32 s65, s65, s43
    buffer_load_dwordx4 v[48:51], v43, s[88:91], s65 offen offset:0
    s_waitcnt vmcnt(5)
    s_add_u32 s65, s15, 0
    s_min_u32 s65, s65, 319
    s_mul_hi_u32 s64, s65, 0x6666667
    s_mul_i32 s64, s64, 40
    s_add_u32 s65, s65, s64
    s_lshl_b32 s65, s65, 10
    s_add_u32 s65, s65, s43
    buffer_load_dwordx4 v[48:51], v43, s[88:91], s65 offen offset:0
    s_waitcnt vmcnt(5)
    s_add_u32 s65, s15, 112
    s_min_u32 s65, s65, 319
    s_mul_hi_u32 s64, s65, 0x6666667
    s_mul_i32 s64, s64, 40
    s_add_u32 s65, s65, s64
    s_lshl_b32 s65, s65, 10
    s_add_u32 s65, s65, s43
    buffer_load_dwordx4 v[48:51], v43, s[88:91], s65 offen offset:0
    s_waitcnt vmcnt(5)
    s_add_u32 s65, s15, 224
    s_min_u32 s65, s65, 319
    s_mul_hi_u32 s64, s65, 0x6666667
    s_mul_i32 s64, s64, 40
    s_add_u32 s65, s65, s64
    s_lshl_b32 s65, s65, 10
    s_add_u32 s65, s65, s43
    buffer_load_dwordx4 v[48:51], v43, s[88:91], s65 offen offset:0
    s_waitcnt vmcnt(5)
    s_mov_b32 s88, s34
    s_and_b32 s89, s35, 0xffff
    s_mov_b32 s90, 0x500000
    s_mov_b32 s91, 0x20000
    s_add_u32 s65, s15, 0
    s_min_u32 s65, s65, 319
    s_mul_hi_u32 s64, s65, 0x6666667
    s_mul_i32 s64, s64, 40
    s_add_u32 s65, s65, s64
    s_add_u32 s65, s65, 40
    s_lshl_b32 s65, s65, 10
    s_add_u32 s65, s65, s43
    buffer_load_dwordx4 v[48:51], v43, s[88:91], s65 offen offset:0
    s_waitcnt vmcnt(5)
    s_add_u32 s65, s15, 112
    s_min_u32 s65, s65, 319
    s_mul_hi_u32 s64, s65, 0x6666667
    s_mul_i32 s64, s64, 40
    s_add_u32 s65, s65, s64
    s_add_u32 s65, s65, 40
    s_lshl_b32 s65, s65, 10
    s_add_u32 s65, s65, s43
    buffer_load_dwordx4 v[48:51], v43, s[88:91], s65 offen offset:0
    s_waitcnt vmcnt(5)
    s_add_u32 s65, s15, 224
    s_min_u32 s65, s65, 319
    s_mul_hi_u32 s64, s65, 0x6666667
    s_mul_i32 s64, s64, 40
    s_add_u32 s65, s65, s64
    s_add_u32 s65, s65, 40
    s_lshl_b32 s65, s65, 10
    s_add_u32 s65, s65, s43
    buffer_load_dwordx4 v[48:51], v43, s[88:91], s65 offen offset:0
    s_waitcnt vmcnt(5)
    s_add_u32 s65, s15, 0
    s_min_u32 s65, s65, 319
    s_mul_hi_u32 s64, s65, 0x6666667
    s_mul_i32 s64, s64, 40
    s_add_u32 s65, s65, s64
    s_lshl_b32 s65, s65, 10
    s_add_u32 s65, s65, s43
    buffer_load_dwordx4 v[48:51], v43, s[88:91], s65 offen offset:0
    s_waitcnt vmcnt(5)
    s_add_u32 s65, s15, 112
    s_min_u32 s65, s65, 319
    s_mul_hi_u32 s64, s65, 0x6666667
    s_mul_i32 s64, s64, 40
    s_add_u32 s65, s65, s64
    s_lshl_b32 s65, s65, 10
    s_add_u32 s65, s65, s43
    buffer_load_dwordx4 v[48:51], v43, s[88:91], s65 offen offset:0
    s_waitcnt vmcnt(5)
    s_add_u32 s65, s15, 224
    s_min_u32 s65, s65, 319
    s_mul_hi_u32 s64, s65, 0x6666667
    s_mul_i32 s64, s64, 40
    s_add_u32 s65, s65, s64
    s_lshl_b32 s65, s65, 10
    s_add_u32 s65, s65, s43
    buffer_load_dwordx4 v[48:51], v43, s[88:91], s65 offen offset:0
    s_waitcnt vmcnt(5)
    s_mov_b32 s88, s32
    s_and_b32 s89, s33, 0xffff
    s_mov_b32 s90, 0x500000
    s_mov_b32 s91, 0x20000
    s_add_u32 s65, s15, 0
    s_min_u32 s65, s65, 639
    s_lshl_b32 s65, s65, 13
    s_add_u32 s65, s65, s42
    buffer_load_dwordx4 v[48:51], v43, s[88:91], s65 offen offset:0
    s_waitcnt vmcnt(5)
    s_add_u32 s65, s15, 112
    s_min_u32 s65, s65, 639
    s_lshl_b32 s65, s65, 13
    s_add_u32 s65, s65, s42
    buffer_load_dwordx4 v[48:51], v43, s[88:91], s65 offen offset:0
    s_waitcnt vmcnt(5)
    s_add_u32 s65, s15, 224
    s_min_u32 s65, s65, 639
    s_lshl_b32 s65, s65, 13
    s_add_u32 s65, s65, s42
    buffer_load_dwordx4 v[48:51], v43, s[88:91], s65 offen offset:0
    s_waitcnt vmcnt(5)
    s_add_u32 s65, s15, 336
    s_min_u32 s65, s65, 639
    s_lshl_b32 s65, s65, 13
    s_add_u32 s65, s65, s42
    buffer_load_dwordx4 v[48:51], v43, s[88:91], s65 offen offset:0
    s_waitcnt vmcnt(5)
    s_add_u32 s65, s15, 448
    s_min_u32 s65, s65, 639
    s_lshl_b32 s65, s65, 13
    s_add_u32 s65, s65, s42
    buffer_load_dwordx4 v[48:51], v43, s[88:91], s65 offen offset:0
    s_waitcnt vmcnt(5)
    s_add_u32 s65, s15, 560
    s_min_u32 s65, s65, 639
    s_lshl_b32 s65, s65, 13
    s_add_u32 s65, s65, s42
    buffer_load_dwordx4 v[48:51], v43, s[88:91], s65 offen offset:0
    s_mov_b32 s88, s24
    s_and_b32 s89, s25, 0xffff
    s_mov_b32 s90, 0x500000
    s_mov_b32 s91, 0x20000
    s_sub_u32 s88, s88, s66
    s_subb_u32 s89, s89, 0
    s_and_b32 s89, s89, 0xffff
    s_add_u32 s90, s90, s66
    s_mov_b32 s92, s34
    s_and_b32 s93, s35, 0xffff
    s_mov_b32 s94, s90
    s_mov_b32 s95, 0x20000
    s_sub_u32 s92, s92, s66
    s_subb_u32 s93, s93, 0
    s_and_b32 s93, s93, 0xffff
    s_mul_i32 s15, s3, 163840
    s_add_u32 s29, s12, 0
    s_min_u32 s29, s29, 79
    s_cmp_lt_u32 s29, 40
    s_cselect_b32 s65, 0, 40
    s_add_u32 s29, s29, s65
    s_lshl_b32 s29, s29, 10
    s_add_u32 s29, s29, s15
    s_add_u32 s30, s12, 28
    s_min_u32 s30, s30, 79
    s_cmp_lt_u32 s30, 40
    s_cselect_b32 s65, 0, 40
    s_add_u32 s30, s30, s65
    s_lshl_b32 s30, s30, 10
    s_add_u32 s30, s30, s15
    s_add_u32 s31, s12, 56
    s_min_u32 s31, s31, 79
    s_cmp_lt_u32 s31, 40
    s_cselect_b32 s65, 0, 40
    s_add_u32 s31, s31, s65
    s_lshl_b32 s31, s31, 10
    s_add_u32 s31, s31, s15
    s_and_b32 s15, s3, 3
    s_lshl_b32 s15, s15, 2
    s_add_u32 s15, s15, s5
    s_mul_i32 s15, s15, 0
    s_mul_hi_u32 s65, s15, 0x1c71c71d
    s_mul_i32 s65, s65, 9
    s_sub_u32 s15, s15, s65
    s_lshl_b32 s15, s15, 12
    s_mov_b32 s16, s15
    s_add_u32 s15, s15, 4096
    s_cmp_eq_u32 s15, 36864
    s_cselect_b32 s15, 0, s15
    s_mov_b32 s17, s15
    s_add_u32 s15, s15, 4096
    s_cmp_eq_u32 s15, 36864
    s_cselect_b32 s15, 0, s15
    s_mov_b32 s18, s15
    s_add_u32 s15, s15, 4096
    s_cmp_eq_u32 s15, 36864
    s_cselect_b32 s15, 0, s15
    s_mov_b32 s19, s15
    s_add_u32 s15, s15, 4096
    s_cmp_eq_u32 s15, 36864
    s_cselect_b32 s15, 0, s15
    s_mov_b32 s20, s15
    s_add_u32 s15, s15, 4096
    s_cmp_eq_u32 s15, 36864
    s_cselect_b32 s15, 0, s15
    s_mov_b32 s21, s15
    s_add_u32 s15, s15, 4096
    s_cmp_eq_u32 s15, 36864
    s_cselect_b32 s15, 0, s15
    s_mov_b32 s22, s15
    s_add_u32 s15, s15, 4096
    s_cmp_eq_u32 s15, 36864
    s_cselect_b32 s15, 0, s15
    s_mov_b32 s23, s15
    s_add_u32 s15, s15, 4096
    s_cmp_eq_u32 s15, 36864
    s_cselect_b32 s15, 0, s15
    s_mov_b32 s24, s15
    s_add_u32 s15, s15, 4096
    s_cmp_eq_u32 s15, 36864
    s_cselect_b32 s15, 0, s15
    s_mov_b32 s25, 36864
    s_add_u32 s64, s7, s16
    s_waitcnt vmcnt(5)
    buffer_load_dwordx4 v[68:71], v1, s[44:47], s64 offen offset:0 nt
    s_waitcnt vmcnt(5)
    buffer_load_dwordx4 v[72:75], v1, s[44:47], s64 offen offset:1024 nt
    s_waitcnt vmcnt(5)
    buffer_load_dwordx4 v[76:79], v1, s[44:47], s64 offen offset:2048 nt
    s_waitcnt vmcnt(5)
    buffer_load_dwordx4 v[80:83], v1, s[44:47], s64 offen offset:3072 nt
    v_and_b32 v44, 1, v47
    v_lshlrev_b32 v44, 4, v44
    v_mov_b32 v7, 0xffff
    v_lshlrev_b32_e64 v7, v44, v7
    v_bfe_u32 v44, v47, 1, 2
    v_cmp_eq_u32 vcc, 0, v44
    s_nop 1
    v_cndmask_b32 v4, 0, v7, vcc
    v_cmp_eq_u32 vcc, 1, v44
    s_nop 1
    v_cndmask_b32 v5, 0, v7, vcc
    v_cmp_eq_u32 vcc, 2, v44
    s_nop 1
    v_cndmask_b32 v6, 0, v7, vcc
    v_cmp_eq_u32 vcc, 3, v44
    s_nop 1
    v_cndmask_b32 v7, 0, v7, vcc
    v_lshlrev_b32 v3, 5, v46
    v_and_b32 v44, 1, v45
    v_lshl_add_u32 v3, v44, 4, v3
    v_lshrrev_b32_e64 v44, 1, v45
    v_lshl_add_u32 v3, v44, 3, v3
    s_lshl_b32 s69, s5, 9
    v_add_u32 v3, s69, v3
    v_mov_b32 v44, 0xff800000
    v_cndmask_b32 v8, v44, 0, s[70:71]
    s_cmp_lg_u32 s9, 0
    s_cbranch_scc1 L_HAS
    v_mov_b32 v8, v44
    v_mov_b32 v212, 0
    v_mov_b32_e64 v36, 0
    v_accvgpr_write_b32 a104, 0
    v_accvgpr_write_b32 a252, 0
    v_mov_b32 v213, 0
    v_mov_b32 v37, 0
    v_accvgpr_write_b32 a105, 0
    v_accvgpr_write_b32 a253, 0
    v_mov_b32 v214, 0
    v_mov_b32 v38, 0
    v_accvgpr_write_b32 a106, 0
    v_accvgpr_write_b32 a254, 0
    v_mov_b32 v215, 0
    v_mov_b32 v39, 0
    v_accvgpr_write_b32 a107, 0
    v_accvgpr_write_b32 a255, 0
    ds_write_b128 v2, v[36:39] offset:36864
    s_waitcnt lgkmcnt(0)
L_HAS:
    s_add_u32 s64, s7, s17
    s_waitcnt vmcnt(5)
    buffer_load_dwordx4 v[84:87], v1, s[44:47], s64 offen offset:0 nt
    s_waitcnt vmcnt(5)
    buffer_load_dwordx4 v[88:91], v1, s[44:47], s64 offen offset:1024 nt
    s_waitcnt vmcnt(5)
    buffer_load_dwordx4 v[92:95], v1, s[44:47], s64 offen offset:2048 nt
    s_waitcnt vmcnt(5)
    buffer_load_dwordx4 v[96:99], v1, s[44:47], s64 offen offset:3072 nt
    s_add_u32 s64, s7, s18
    s_waitcnt vmcnt(5)
    buffer_load_dwordx4 v[100:103], v1, s[44:47], s64 offen offset:0 nt
    s_waitcnt vmcnt(5)
    buffer_load_dwordx4 v[104:107], v1, s[44:47], s64 offen offset:1024 nt
    s_waitcnt vmcnt(5)
    buffer_load_dwordx4 v[108:111], v1, s[44:47], s64 offen offset:2048 nt
    s_waitcnt vmcnt(5)
    buffer_load_dwordx4 v[112:115], v1, s[44:47], s64 offen offset:3072 nt
    s_cmp_lg_u32 s5, 0
    s_cbranch_scc1 L_NOFLAG
    v_mov_b32_e64 v41, 0
    s_lshr_b32 s65, s3, 2
    s_lshl_b32 s65, s65, 5
    v_mov_b32 v40, s99
    s_mov_b64 exec, 1
    buffer_atomic_add v40, v41, s[84:87], s65 offen offset:4 sc1
    s_mov_b64 exec, -1
L_NOFLAG:
    s_add_u32 s64, s7, s19
    s_waitcnt vmcnt(5)
    buffer_load_dwordx4 v[116:119], v1, s[44:47], s64 offen offset:0 nt
    s_waitcnt vmcnt(5)
    buffer_load_dwordx4 v[120:123], v1, s[44:47], s64 offen offset:1024 nt
    s_waitcnt vmcnt(5)
    buffer_load_dwordx4 v[124:127], v1, s[44:47], s64 offen offset:2048 nt
    s_waitcnt vmcnt(5)
    buffer_load_dwordx4 v[128:131], v1, s[44:47], s64 offen offset:3072 nt
    s_add_u32 s64, s7, s20
    s_waitcnt vmcnt(5)
    buffer_load_dwordx4 v[132:135], v1, s[44:47], s64 offen offset:0 nt
    s_waitcnt vmcnt(5)
    buffer_load_dwordx4 v[136:139], v1, s[44:47], s64 offen offset:1024 nt
    s_waitcnt vmcnt(5)
    buffer_load_dwordx4 v[140:143], v1, s[44:47], s64 offen offset:2048 nt
    s_waitcnt vmcnt(5)
    buffer_load_dwordx4 v[144:147], v1, s[44:47], s64 offen offset:3072 nt
    s_add_u32 s64, s7, s21
    s_waitcnt vmcnt(5)
    buffer_load_dwordx4 v[148:151], v1, s[44:47], s64 offen offset:0 nt
    s_waitcnt vmcnt(5)
    buffer_load_dwordx4 v[152:155], v1, s[44:47], s64 offen offset:1024 nt
    s_waitcnt vmcnt(5)
    buffer_load_dwordx4 v[156:159], v1, s[44:47], s64 offen offset:2048 nt
    s_waitcnt vmcnt(5)
    buffer_load_dwordx4 v[160:163], v1, s[44:47], s64 offen offset:3072 nt
    s_add_u32 s64, s7, s22
    s_waitcnt vmcnt(5)
    buffer_load_dwordx4 v[164:167], v1, s[44:47], s64 offen offset:0 nt
    s_waitcnt vmcnt(5)
    buffer_load_dwordx4 v[168:171], v1, s[44:47], s64 offen offset:1024 nt
    s_waitcnt vmcnt(5)
    buffer_load_dwordx4 v[172:175], v1, s[44:47], s64 offen offset:2048 nt
    s_waitcnt vmcnt(5)
    buffer_load_dwordx4 v[176:179], v1, s[44:47], s64 offen offset:3072 nt
    s_add_u32 s64, s7, s23
    s_waitcnt vmcnt(5)
    buffer_load_dwordx4 v[180:183], v1, s[44:47], s64 offen offset:0 nt
    s_waitcnt vmcnt(5)
    buffer_load_dwordx4 v[184:187], v1, s[44:47], s64 offen offset:1024 nt
    s_waitcnt vmcnt(5)
    buffer_load_dwordx4 v[188:191], v1, s[44:47], s64 offen offset:2048 nt
    s_waitcnt vmcnt(5)
    buffer_load_dwordx4 v[192:195], v1, s[44:47], s64 offen offset:3072 nt
    s_add_u32 s64, s7, s24
    s_waitcnt vmcnt(5)
    buffer_load_dwordx4 v[196:199], v1, s[44:47], s64 offen offset:0 nt
    s_waitcnt vmcnt(5)
    buffer_load_dwordx4 v[200:203], v1, s[44:47], s64 offen offset:1024 nt
    s_waitcnt vmcnt(5)
    buffer_load_dwordx4 v[204:207], v1, s[44:47], s64 offen offset:2048 nt
    s_waitcnt vmcnt(5)
    buffer_load_dwordx4 v[208:211], v1, s[44:47], s64 offen offset:3072 nt
    s_add_u32 s64, s7, s25
    s_waitcnt vmcnt(5)
    s_cmp_eq_u32 s9, 0
    s_cbranch_scc1 NT_1
    buffer_load_dwordx4 v[212:215], v1, s[44:47], s64 offen offset:0 nt
NT_1:
    v_and_b32 v41, 7, v47
    v_lshlrev_b32 v41, 5, v41
    buffer_load_dword v40, v41, s[84:87], 0 offen offset:4 sc1
    s_add_u32 s67, s7, s16
    s_add_u32 m0, s66, 0
    v_nop_e64
    buffer_load_dwordx4 v2, s[48:51], s67 offen offset:0 nt lds
    s_waitcnt vmcnt(6)
    buffer_load_dwordx4 v2, s[48:51], s67 offen offset:1024 nt lds
    s_waitcnt vmcnt(6)
    buffer_load_dwordx4 v2, s[48:51], s67 offen offset:2048 nt lds
    s_waitcnt vmcnt(6)
    buffer_load_dwordx4 v2, s[48:51], s67 offen offset:3072 nt lds
    s_add_u32 s67, s7, s17
    s_add_u32 m0, s66, 4096
    s_waitcnt vmcnt(6)
    buffer_load_dwordx4 v2, s[48:51], s67 offen offset:0 nt lds
    s_waitcnt vmcnt(6)
    buffer_load_dwordx4 v2, s[48:51], s67 offen offset:1024 nt lds
    s_waitcnt vmcnt(5)
    buffer_load_dwordx4 v2, s[48:51], s67 offen offset:2048 nt lds
    v_and_b32 v39, 0xffff, v40
    v_cmp_gt_u32 vcc, 32, v39
    s_cbranch_vccz L_FLD
L_FLW:
    buffer_load_dword v40, v41, s[84:87], 0 offen offset:4 sc1
    s_waitcnt vmcnt(0)
    v_and_b32 v39, 0xffff, v40
    v_cmp_gt_u32 vcc, 32, v39
    s_cbranch_vccz L_FLD
    s_cmp_eq_u32 s62, 0
    s_cbranch_scc1 L_FLD
    s_sub_u32 s62, s62, 1
    s_sleep 2
    s_branch L_FLW
L_FLD:
    v_cmp_eq_u32 vcc, 32, v40
    s_lshr_b32 s65, s3, 2
    s_nop 3
    s_lshr_b32 s65, vcc_lo, s65
    s_and_b32 s79, s65, 1
    s_waitcnt vmcnt(5)
    buffer_load_dwordx4 v2, s[48:51], s67 offen offset:3072 nt lds
    s_add_u32 s67, s7, s18
    s_add_u32 m0, s66, 8192
    s_waitcnt vmcnt(5)
    buffer_load_dwordx4 v2, s[48:51], s67 offen offset:0 nt lds
    s_waitcnt vmcnt(5)
    buffer_load_dwordx4 v2, s[48:51], s67 offen offset:1024 nt lds
    s_waitcnt vmcnt(5)
    buffer_load_dwordx4 v2, s[48:51], s67 offen offset:2048 nt lds
    s_waitcnt vmcnt(5)
    buffer_load_dwordx4 v2, s[48:51], s67 offen offset:3072 nt lds
    s_add_u32 s67, s7, s19
    s_add_u32 m0, s66, 12288
    s_waitcnt vmcnt(5)
    buffer_load_dwordx4 v2, s[48:51], s67 offen offset:0 nt lds
    s_waitcnt vmcnt(5)
    buffer_load_dwordx4 v2, s[48:51], s67 offen offset:1024 nt lds
    s_waitcnt vmcnt(5)
    buffer_load_dwordx4 v2, s[48:51], s67 offen offset:2048 nt lds
    s_waitcnt vmcnt(5)
    buffer_load_dwordx4 v2, s[48:51], s67 offen offset:3072 nt lds
    s_add_u32 s67, s7, s20
    s_add_u32 m0, s66, 16384
    s_waitcnt vmcnt(5)
    buffer_load_dwordx4 v2, s[48:51], s67 offen offset:0 nt lds
    s_waitcnt vmcnt(5)
    buffer_load_dwordx4 v2, s[48:51], s67 offen offset:1024 nt lds
    s_waitcnt vmcnt(5)
    buffer_load_dwordx4 v2, s[48:51], s67 offen offset:2048 nt lds
    s_waitcnt vmcnt(5)
    buffer_load_dwordx4 v2, s[48:51], s67 offen offset:3072 nt lds
    s_add_u32 s67, s7, s21
    s_add_u32 m0, s66, 20480
    s_waitcnt vmcnt(5)
    buffer_load_dwordx4 v2, s[48:51], s67 offen offset:0 nt lds
    s_waitcnt vmcnt(5)
    buffer_load_dwordx4 v2, s[48:51], s67 offen offset:1024 nt lds
    s_waitcnt vmcnt(5)
    buffer_load_dwordx4 v2, s[48:51], s67 offen offset:2048 nt lds
    s_waitcnt vmcnt(5)
    buffer_load_dwordx4 v2, s[48:51], s67 offen offset:3072 nt lds
    s_lshr_b32 s36, s3, 2
    s_lshl_b32 s36, s36, 7
    s_add_u32 s36, s36, 184320
    s_mov_b64 s[34:35], 0
L_J:
    s_add_u32 s67, s7, s22
    s_add_u32 m0, s66, 24576
    s_waitcnt vmcnt(6)
    buffer_load_dwordx4 v2, s[48:51], s67 offen offset:0 nt lds
    s_waitcnt vmcnt(6)
    buffer_load_dwordx4 v2, s[48:51], s67 offen offset:1024 nt lds
    s_cmp_eq_u32 s6, 0
    s_cselect_b32 s15, 0, 185344
    s_sub_u32 s15, s10, s15
    buffer_load_dwordx4 v[52:55], v19, s[80:83], s15 offen sc1
    s_waitcnt vmcnt(7)
    buffer_load_dwordx4 v2, s[48:51], s67 offen offset:2048 nt lds
    s_waitcnt vmcnt(7)
    buffer_load_dwordx4 v2, s[48:51], s67 offen offset:3072 nt lds
    s_add_u32 s67, s7, s23
    s_add_u32 m0, s66, 28672
    s_waitcnt vmcnt(7)
    buffer_load_dwordx4 v2, s[48:51], s67 offen offset:0 nt lds
    s_waitcnt vmcnt(7)
    buffer_load_dwordx4 v2, s[48:51], s67 offen offset:1024 nt lds
    s_waitcnt vmcnt(7)
    buffer_load_dwordx4 v2, s[48:51], s67 offen offset:2048 nt lds
    s_waitcnt vmcnt(7)
    buffer_load_dwordx4 v2, s[48:51], s67 offen offset:3072 nt lds
    s_add_u32 s67, s7, s24
    s_add_u32 m0, s66, 32768
    s_waitcnt vmcnt(7)
    buffer_load_dwordx4 v2, s[48:51], s67 offen offset:0 nt lds
    s_cmp_eq_u32 s6, 0
    s_cbranch_scc1 L_B0
    s_waitcnt vmcnt(7)
    v_max3_u32 v22, v52, v53, v54
    v_max3_u32 v22, v22, v55, v55
    v_cmp_eq_u32 vcc, -1, v22
    s_cbranch_vccz L_Q4D
    s_mov_b32 s26, s7
    s_add_u32 s27, s7, 16384
QA_2:
    s_cmp_ge_u32 s26, s27
    s_cbranch_scc1 QB_3
    buffer_load_dwordx4 v[52:55], v19, s[80:83], s15 offen sc1
    s_waitcnt vmcnt(10)
    buffer_load_dwordx4 v[48:51], v1, s[52:55], s26 offen offset:0
    s_waitcnt vmcnt(10)
    buffer_load_dwordx4 v[48:51], v1, s[52:55], s26 offen offset:1024
    s_add_u32 s26, s26, 2048
    v_max3_u32 v22, v52, v53, v54
    v_max3_u32 v22, v22, v55, v55
    v_cmp_eq_u32_e64 vcc, -1, v22
    s_cbranch_vccnz QA_2
    s_branch L_Q4D
QB_3:
    buffer_load_dwordx4 v[52:55], v19, s[80:83], s15 offen sc1
    s_waitcnt vmcnt(0)
    v_max3_u32 v22, v52, v53, v54
    v_max3_u32 v22, v22, v55, v55
    v_cmp_eq_u32 vcc, -1, v22
    s_cbranch_vccz L_Q4D
    s_cmp_eq_u32 s62, 0
    s_cbranch_scc1 L_Q4D
    s_sub_u32 s62, s62, 1
    s_branch QB_3
L_Q4D:
    s_nop 0
    v_cndmask_b32 v32, 0, v52, s[70:71]
    v_cndmask_b32 v33, 0, v53, s[70:71]
    v_cndmask_b32 v34, 0, v54, s[70:71]
    v_cndmask_b32 v35, 0, v55, s[70:71]
    v_cndmask_b32 v36, 0, v52, s[72:73]
    v_cndmask_b32 v37, 0, v53, s[72:73]
    v_cndmask_b32 v38, 0, v54, s[72:73]
    v_cndmask_b32 v39, 0, v55, s[72:73]
    v_cndmask_b32 v40, 0, v52, s[74:75]
    v_cndmask_b32 v41, 0, v53, s[74:75]
    v_cndmask_b32 v42, 0, v54, s[74:75]
    v_cndmask_b32 v43, 0, v55, s[74:75]
    v_cndmask_b32 v44, 0, v52, s[76:77]
    v_cndmask_b32 v45, 0, v53, s[76:77]
    v_cndmask_b32 v46, 0, v54, s[76:77]
    v_cndmask_b32 v47, 0, v55, s[76:77]
    s_add_u32 s65, s10, 0
    s_nop 0
    buffer_load_dwordx4 v[48:51], v19, s[80:83], s65 offen sc1
    v_mfma_f32_16x16x32_bf16 v[24:27], v[216:219], v[32:35], 0
    v_mfma_f32_16x16x32_bf16 v[24:27], v[220:223], v[36:39], v[24:27]
    v_mfma_f32_16x16x32_bf16 v[24:27], v[224:227], v[40:43], v[24:27]
    v_mfma_f32_16x16x32_bf16 v[24:27], v[228:231], v[44:47], v[24:27]
    buffer_load_dwordx4 v2, s[48:51], s67 offen offset:1024 nt lds
    buffer_load_dwordx4 v2, s[48:51], s67 offen offset:2048 nt lds
    v_mfma_f32_16x16x32_bf16 v[20:23], v[232:235], v[32:35], 0
    v_mfma_f32_16x16x32_bf16 v[20:23], v[236:239], v[36:39], v[20:23]
    v_mfma_f32_16x16x32_bf16 v[20:23], v[240:243], v[40:43], v[20:23]
    v_mfma_f32_16x16x32_bf16 v[20:23], v[244:247], v[44:47], v[20:23]
    v_mfma_f32_16x16x32_bf16 v[28:31], v[248:251], v[32:35], 0
    v_nop_e64
    v_mov_b32_dpp v9, v24 quad_perm:[0,0,0,0] row_mask:0xf bank_mask:0xf
    v_mfma_f32_16x16x32_bf16 v[28:31], v[252:255], v[36:39], v[28:31]
    v_nop_e64
    v_add_f32_dpp v9, v25, v9 quad_perm:[1,1,1,1] row_mask:0xf bank_mask:0xf
    v_mfma_f32_16x16x32_bf16 v[28:31], a[0:3], v[40:43], v[28:31]
    v_nop_e64
    v_add_f32_dpp v9, v26, v9 quad_perm:[2,2,2,2] row_mask:0xf bank_mask:0xf
    v_mfma_f32_16x16x32_bf16 v[28:31], a[4:7], v[44:47], v[28:31]
    v_nop_e64
    v_add_f32_dpp v9, v27, v9 quad_perm:[3,3,3,3] row_mask:0xf bank_mask:0xf
    buffer_load_dwordx4 v2, s[48:51], s67 offen offset:3072 nt lds
    v_mfma_f32_16x16x32_bf16 v[24:27], a[8:11], v[32:35], 0
    v_mov_b32_dpp v10, v20 quad_perm:[0,0,0,0] row_mask:0xf bank_mask:0xf
    v_mfma_f32_16x16x32_bf16 v[24:27], a[12:15], v[36:39], v[24:27]
    v_nop_e64
    v_add_f32_dpp v10, v21, v10 quad_perm:[1,1,1,1] row_mask:0xf bank_mask:0xf
    v_mfma_f32_16x16x32_bf16 v[24:27], a[16:19], v[40:43], v[24:27]
    v_nop_e64
    v_add_f32_dpp v10, v22, v10 quad_perm:[2,2,2,2] row_mask:0xf bank_mask:0xf
    v_mfma_f32_16x16x32_bf16 v[24:27], a[20:23], v[44:47], v[24:27]
    v_nop_e64
    v_add_f32_dpp v10, v23, v10 quad_perm:[3,3,3,3] row_mask:0xf bank_mask:0xf
    v_mfma_f32_16x16x32_bf16 v[20:23], a[24:27], v[32:35], 0
    v_mov_b32_dpp v11, v28 quad_perm:[0,0,0,0] row_mask:0xf bank_mask:0xf
    v_mfma_f32_16x16x32_bf16 v[20:23], a[28:31], v[36:39], v[20:23]
    v_nop_e64
    v_add_f32_dpp v11, v29, v11 quad_perm:[1,1,1,1] row_mask:0xf bank_mask:0xf
    v_mfma_f32_16x16x32_bf16 v[20:23], a[32:35], v[40:43], v[20:23]
    v_nop_e64
    v_add_f32_dpp v11, v30, v11 quad_perm:[2,2,2,2] row_mask:0xf bank_mask:0xf
    v_mfma_f32_16x16x32_bf16 v[20:23], a[36:39], v[44:47], v[20:23]
    v_nop_e64
    v_add_f32_dpp v11, v31, v11 quad_perm:[3,3,3,3] row_mask:0xf bank_mask:0xf
    v_mfma_f32_16x16x32_bf16 v[28:31], a[40:43], v[32:35], 0
    v_mov_b32_dpp v12, v24 quad_perm:[0,0,0,0] row_mask:0xf bank_mask:0xf
    v_mfma_f32_16x16x32_bf16 v[28:31], a[44:47], v[36:39], v[28:31]
    v_nop_e64
    v_add_f32_dpp v12, v25, v12 quad_perm:[1,1,1,1] row_mask:0xf bank_mask:0xf
    v_mfma_f32_16x16x32_bf16 v[28:31], a[48:51], v[40:43], v[28:31]
    v_nop_e64
    v_add_f32_dpp v12, v26, v12 quad_perm:[2,2,2,2] row_mask:0xf bank_mask:0xf
    v_mfma_f32_16x16x32_bf16 v[28:31], a[52:55], v[44:47], v[28:31]
    v_nop_e64
    v_add_f32_dpp v12, v27, v12 quad_perm:[3,3,3,3] row_mask:0xf bank_mask:0xf
    s_add_u32 s67, s7, s25
    s_add_u32 m0, s66, 36864
    s_cmp_eq_u32 s9, 0
    s_cbranch_scc1 NT_4
    buffer_load_dwordx4 v2, s[48:51], s67 offen offset:0 nt lds
NT_4:
    v_mfma_f32_16x16x32_bf16 v[24:27], a[56:59], v[32:35], 0
    v_mov_b32_dpp v13, v20 quad_perm:[0,0,0,0] row_mask:0xf bank_mask:0xf
    v_mfma_f32_16x16x32_bf16 v[24:27], a[60:63], v[36:39], v[24:27]
    s_nop 0
    v_add_f32_dpp v13, v21, v13 quad_perm:[1,1,1,1] row_mask:0xf bank_mask:0xf
    v_mfma_f32_16x16x32_bf16 v[24:27], a[64:67], v[40:43], v[24:27]
    v_nop_e64
    v_add_f32_dpp v13, v22, v13 quad_perm:[2,2,2,2] row_mask:0xf bank_mask:0xf
    v_mfma_f32_16x16x32_bf16 v[24:27], a[68:71], v[44:47], v[24:27]
    v_nop_e64
    v_add_f32_dpp v13, v23, v13 quad_perm:[3,3,3,3] row_mask:0xf bank_mask:0xf
    v_mfma_f32_16x16x32_bf16 v[20:23], a[72:75], v[32:35], 0
    v_mov_b32_dpp v14, v28 quad_perm:[0,0,0,0] row_mask:0xf bank_mask:0xf
    v_mfma_f32_16x16x32_bf16 v[20:23], a[76:79], v[36:39], v[20:23]
    v_nop_e64
    v_add_f32_dpp v14, v29, v14 quad_perm:[1,1,1,1] row_mask:0xf bank_mask:0xf
    v_mfma_f32_16x16x32_bf16 v[20:23], a[80:83], v[40:43], v[20:23]
    v_nop_e64
    v_add_f32_dpp v14, v30, v14 quad_perm:[2,2,2,2] row_mask:0xf bank_mask:0xf
    v_mfma_f32_16x16x32_bf16 v[20:23], a[84:87], v[44:47], v[20:23]
    v_nop_e64
    v_add_f32_dpp v14, v31, v14 quad_perm:[3,3,3,3] row_mask:0xf bank_mask:0xf
    v_mfma_f32_16x16x32_bf16 v[28:31], a[88:91], v[32:35], 0
    v_mov_b32_dpp v15, v24 quad_perm:[0,0,0,0] row_mask:0xf bank_mask:0xf
    v_mfma_f32_16x16x32_bf16 v[28:31], a[92:95], v[36:39], v[28:31]
    v_nop_e64
    v_add_f32_dpp v15, v25, v15 quad_perm:[1,1,1,1] row_mask:0xf bank_mask:0xf
    v_mfma_f32_16x16x32_bf16 v[28:31], a[96:99], v[40:43], v[28:31]
    v_nop_e64
    v_add_f32_dpp v15, v26, v15 quad_perm:[2,2,2,2] row_mask:0xf bank_mask:0xf
    v_mfma_f32_16x16x32_bf16 v[28:31], a[100:103], v[44:47], v[28:31]
    v_nop_e64
    v_add_f32_dpp v15, v27, v15 quad_perm:[3,3,3,3] row_mask:0xf bank_mask:0xf
    s_add_u32 s64, s7, s16
    buffer_load_dwordx4 v[216:219], v1, s[52:55], s64 offen offset:0 nt
    v_mfma_f32_16x16x32_bf16 v[24:27], a[104:107], v[32:35], 0
    v_mov_b32_dpp v16, v20 quad_perm:[0,0,0,0] row_mask:0xf bank_mask:0xf
    s_nop 1
    v_add_f32_dpp v16, v21, v16 quad_perm:[1,1,1,1] row_mask:0xf bank_mask:0xf
    s_nop 0
    s_nop 0
    v_add_f32_dpp v16, v22, v16 quad_perm:[2,2,2,2] row_mask:0xf bank_mask:0xf
    s_nop 0
    s_nop 0
    v_add_f32_dpp v16, v23, v16 quad_perm:[3,3,3,3] row_mask:0xf bank_mask:0xf
    v_mov_b32_dpp v17, v28 quad_perm:[0,0,0,0] row_mask:0xf bank_mask:0xf
    v_add_f32_dpp v18, v24, v8 quad_perm:[0,0,0,0] row_mask:0xf bank_mask:0xf
    v_nop_e64
    v_add_f32_dpp v17, v29, v17 quad_perm:[1,1,1,1] row_mask:0xf bank_mask:0xf
    v_add_f32_dpp v18, v25, v18 quad_perm:[1,1,1,1] row_mask:0xf bank_mask:0xf
    v_nop_e64
    v_add_f32_dpp v17, v30, v17 quad_perm:[2,2,2,2] row_mask:0xf bank_mask:0xf
    v_add_f32_dpp v18, v26, v18 quad_perm:[2,2,2,2] row_mask:0xf bank_mask:0xf
    v_nop_e64
    v_add_f32_dpp v17, v31, v17 quad_perm:[3,3,3,3] row_mask:0xf bank_mask:0xf
    v_add_f32_dpp v18, v27, v18 quad_perm:[3,3,3,3] row_mask:0xf bank_mask:0xf
    v_max3_f32 v20, v9, v10, v11
    v_max3_f32 v21, v12, v13, v14
    v_max3_f32 v20, v20, v15, v16
    v_max3_f32 v21, v21, v17, v18
    v_max_f32 v20, v20, v21
    s_nop 1
    v_max_f32_dpp v20, v20, v20 row_ror:4 row_mask:0xf bank_mask:0xf
    s_nop 0
    s_nop 0
    v_max_f32_dpp v20, v20, v20 row_ror:8 row_mask:0xf bank_mask:0xf
    v_mov_b32 v23, v20
    s_nop 1
    v_permlane16_swap_b32 v20, v23
    v_max_f32 v20, v20, v23
    v_mov_b32 v23, v20
    s_nop 1
    v_permlane32_swap_b32 v20, v23
    v_max_f32 v20, v20, v23
    v_mul_f32_e64 v20, s63, v20
    v_fma_f32 v9, v9, s63, -v20
    v_fma_f32 v10, v10, s63, -v20
    v_fma_f32 v11, v11, s63, -v20
    v_fma_f32 v12, v12, s63, -v20
    v_fma_f32 v13, v13, s63, -v20
    v_fma_f32 v14, v14, s63, -v20
    v_fma_f32 v15, v15, s63, -v20
    v_fma_f32 v16, v16, s63, -v20
    v_fma_f32 v17, v17, s63, -v20
    v_fma_f32 v18, v18, s63, -v20
    v_exp_f32 v9, v9
    v_exp_f32 v10, v10
    v_exp_f32 v11, v11
    v_exp_f32 v12, v12
    v_exp_f32 v13, v13
    v_exp_f32 v14, v14
    v_exp_f32 v15, v15
    v_exp_f32 v16, v16
    v_exp_f32 v17, v17
    v_exp_f32 v18, v18
    v_add_f32 v21, v9, v10
    v_add_f32 v21, v21, v11
    v_add_f32 v21, v21, v12
    v_add_f32 v21, v21, v13
    v_add_f32 v21, v21, v14
    v_add_f32 v21, v21, v15
    v_add_f32 v21, v21, v16
    v_add_f32 v21, v21, v17
    v_add_f32_e64 v21, v21, v18
    v_cvt_pk_bf16_f32 v9, v9, v9
    v_cvt_pk_bf16_f32 v10, v10, v10
    v_cvt_pk_bf16_f32 v11, v11, v11
    v_cvt_pk_bf16_f32 v12, v12, v12
    v_cvt_pk_bf16_f32 v13, v13, v13
    v_cvt_pk_bf16_f32 v14, v14, v14
    v_cvt_pk_bf16_f32 v15, v15, v15
    v_cvt_pk_bf16_f32 v16, v16, v16
    v_cvt_pk_bf16_f32 v17, v17, v17
    v_cvt_pk_bf16_f32 v18, v18, v18
    v_and_b32 v40, v9, v4
    v_and_b32 v41, v9, v5
    v_and_b32_dpp v42, v9, v6 row_ror:4 row_mask:0xf bank_mask:0xf
    v_and_b32_dpp v43, v9, v7 row_ror:4 row_mask:0xf bank_mask:0xf
    v_and_b32_dpp v44, v9, v4 row_ror:12 row_mask:0xf bank_mask:0xf
    v_and_b32_dpp v45, v9, v5 row_ror:12 row_mask:0xf bank_mask:0xf
    v_mfma_f32_16x16x32_bf16 v[32:35], v[40:43], a[108:111], 0
    v_and_b32 v46, v9, v6
    v_and_b32 v47, v9, v7
    v_mfma_f32_16x16x32_bf16 v[36:39], v[40:43], a[116:119], 0
    v_and_b32 v40, v10, v4
    v_and_b32 v41, v10, v5
    v_mfma_f32_16x16x32_bf16 v[32:35], v[44:47], a[112:115], v[32:35]
    v_and_b32_dpp v42, v10, v6 row_ror:4 row_mask:0xf bank_mask:0xf
    v_and_b32_dpp v43, v10, v7 row_ror:4 row_mask:0xf bank_mask:0xf
    v_mfma_f32_16x16x32_bf16 v[36:39], v[44:47], a[120:123], v[36:39]
    buffer_load_dwordx4 v[220:223], v1, s[52:55], s64 offen offset:1024 nt
    v_and_b32_dpp v44, v10, v4 row_ror:12 row_mask:0xf bank_mask:0xf
    v_and_b32_dpp v45, v10, v5 row_ror:12 row_mask:0xf bank_mask:0xf
    v_mfma_f32_16x16x32_bf16 v[32:35], v[40:43], a[124:127], v[32:35]
    v_and_b32 v46, v10, v6
    v_and_b32 v47, v10, v7
    v_mfma_f32_16x16x32_bf16 v[36:39], v[40:43], a[132:135], v[36:39]
    v_and_b32 v40, v11, v4
    v_and_b32 v41, v11, v5
    v_mfma_f32_16x16x32_bf16 v[32:35], v[44:47], a[128:131], v[32:35]
    v_and_b32_dpp v42, v11, v6 row_ror:4 row_mask:0xf bank_mask:0xf
    v_and_b32_dpp v43, v11, v7 row_ror:4 row_mask:0xf bank_mask:0xf
    v_mfma_f32_16x16x32_bf16 v[36:39], v[44:47], a[136:139], v[36:39]
    v_and_b32_dpp v44, v11, v4 row_ror:12 row_mask:0xf bank_mask:0xf
    v_and_b32_dpp v45, v11, v5 row_ror:12 row_mask:0xf bank_mask:0xf
    v_mfma_f32_16x16x32_bf16 v[32:35], v[40:43], a[140:143], v[32:35]
    v_and_b32 v46, v11, v6
    v_and_b32 v47, v11, v7
    v_mfma_f32_16x16x32_bf16 v[36:39], v[40:43], a[148:151], v[36:39]
    v_and_b32 v40, v12, v4
    v_and_b32 v41, v12, v5
    v_mfma_f32_16x16x32_bf16 v[32:35], v[44:47], a[144:147], v[32:35]
    v_and_b32_dpp v42, v12, v6 row_ror:4 row_mask:0xf bank_mask:0xf
    v_and_b32_dpp v43, v12, v7 row_ror:4 row_mask:0xf bank_mask:0xf
    v_mfma_f32_16x16x32_bf16 v[36:39], v[44:47], a[152:155], v[36:39]
    v_and_b32_dpp v44, v12, v4 row_ror:12 row_mask:0xf bank_mask:0xf
    v_and_b32_dpp v45, v12, v5 row_ror:12 row_mask:0xf bank_mask:0xf
    v_mfma_f32_16x16x32_bf16 v[32:35], v[40:43], a[156:159], v[32:35]
    v_and_b32 v46, v12, v6
    v_and_b32 v47, v12, v7
    v_mfma_f32_16x16x32_bf16 v[36:39], v[40:43], a[164:167], v[36:39]
    v_and_b32 v40, v13, v4
    v_and_b32 v41, v13, v5
    v_mfma_f32_16x16x32_bf16 v[32:35], v[44:47], a[160:163], v[32:35]
    v_and_b32_dpp v42, v13, v6 row_ror:4 row_mask:0xf bank_mask:0xf
    v_and_b32_dpp v43, v13, v7 row_ror:4 row_mask:0xf bank_mask:0xf
    v_mfma_f32_16x16x32_bf16 v[36:39], v[44:47], a[168:171], v[36:39]
    buffer_load_dwordx4 v[224:227], v1, s[52:55], s64 offen offset:2048 nt
    v_and_b32_dpp v44, v13, v4 row_ror:12 row_mask:0xf bank_mask:0xf
    v_and_b32_dpp v45, v13, v5 row_ror:12 row_mask:0xf bank_mask:0xf
    v_mfma_f32_16x16x32_bf16 v[32:35], v[40:43], a[172:175], v[32:35]
    v_and_b32 v46, v13, v6
    v_and_b32 v47, v13, v7
    v_mfma_f32_16x16x32_bf16 v[36:39], v[40:43], a[180:183], v[36:39]
    v_and_b32 v40, v14, v4
    v_and_b32 v41, v14, v5
    v_mfma_f32_16x16x32_bf16 v[32:35], v[44:47], a[176:179], v[32:35]
    v_and_b32_dpp v42, v14, v6 row_ror:4 row_mask:0xf bank_mask:0xf
    v_and_b32_dpp v43, v14, v7 row_ror:4 row_mask:0xf bank_mask:0xf
    v_mfma_f32_16x16x32_bf16 v[36:39], v[44:47], a[184:187], v[36:39]
    v_and_b32_dpp v44, v14, v4 row_ror:12 row_mask:0xf bank_mask:0xf
    v_and_b32_dpp v45, v14, v5 row_ror:12 row_mask:0xf bank_mask:0xf
    v_mfma_f32_16x16x32_bf16 v[32:35], v[40:43], a[188:191], v[32:35]
    v_and_b32 v46, v14, v6
    v_and_b32 v47, v14, v7
    v_mfma_f32_16x16x32_bf16 v[36:39], v[40:43], a[196:199], v[36:39]
    v_and_b32 v40, v15, v4
    v_and_b32 v41, v15, v5
    v_mfma_f32_16x16x32_bf16 v[32:35], v[44:47], a[192:195], v[32:35]
    v_and_b32_dpp v42, v15, v6 row_ror:4 row_mask:0xf bank_mask:0xf
    v_and_b32_dpp v43, v15, v7 row_ror:4 row_mask:0xf bank_mask:0xf
    v_mfma_f32_16x16x32_bf16 v[36:39], v[44:47], a[200:203], v[36:39]
    v_and_b32_dpp v44, v15, v4 row_ror:12 row_mask:0xf bank_mask:0xf
    v_and_b32_dpp v45, v15, v5 row_ror:12 row_mask:0xf bank_mask:0xf
    v_mfma_f32_16x16x32_bf16 v[32:35], v[40:43], a[204:207], v[32:35]
    v_and_b32 v46, v15, v6
    v_and_b32 v47, v15, v7
    v_mfma_f32_16x16x32_bf16 v[36:39], v[40:43], a[212:215], v[36:39]
    v_and_b32 v40, v16, v4
    v_and_b32 v41, v16, v5
    v_mfma_f32_16x16x32_bf16 v[32:35], v[44:47], a[208:211], v[32:35]
    v_and_b32_dpp v42, v16, v6 row_ror:4 row_mask:0xf bank_mask:0xf
    v_and_b32_dpp v43, v16, v7 row_ror:4 row_mask:0xf bank_mask:0xf
    v_mfma_f32_16x16x32_bf16 v[36:39], v[44:47], a[216:219], v[36:39]
    buffer_load_dwordx4 v[228:231], v1, s[52:55], s64 offen offset:3072 nt
    v_and_b32_dpp v44, v16, v4 row_ror:12 row_mask:0xf bank_mask:0xf
    v_and_b32_dpp v45, v16, v5 row_ror:12 row_mask:0xf bank_mask:0xf
    v_mfma_f32_16x16x32_bf16 v[32:35], v[40:43], a[220:223], v[32:35]
    v_and_b32 v46, v16, v6
    v_and_b32 v47, v16, v7
    v_mfma_f32_16x16x32_bf16 v[36:39], v[40:43], a[228:231], v[36:39]
    v_and_b32 v40, v17, v4
    v_and_b32 v41, v17, v5
    v_mfma_f32_16x16x32_bf16 v[32:35], v[44:47], a[224:227], v[32:35]
    v_and_b32_dpp v42, v17, v6 row_ror:4 row_mask:0xf bank_mask:0xf
    v_and_b32_dpp v43, v17, v7 row_ror:4 row_mask:0xf bank_mask:0xf
    v_mfma_f32_16x16x32_bf16 v[36:39], v[44:47], a[232:235], v[36:39]
    v_and_b32_dpp v44, v17, v4 row_ror:12 row_mask:0xf bank_mask:0xf
    v_and_b32_dpp v45, v17, v5 row_ror:12 row_mask:0xf bank_mask:0xf
    v_mfma_f32_16x16x32_bf16 v[32:35], v[40:43], a[236:239], v[32:35]
    v_and_b32 v46, v17, v6
    v_and_b32 v47, v17, v7
    v_mfma_f32_16x16x32_bf16 v[36:39], v[40:43], a[244:247], v[36:39]
    v_and_b32 v40, v18, v4
    v_and_b32 v41, v18, v5
    v_mfma_f32_16x16x32_bf16 v[32:35], v[44:47], a[240:243], v[32:35]
    v_and_b32_dpp v42, v18, v6 row_ror:4 row_mask:0xf bank_mask:0xf
    v_and_b32_dpp v43, v18, v7 row_ror:4 row_mask:0xf bank_mask:0xf
    v_mfma_f32_16x16x32_bf16 v[36:39], v[44:47], a[248:251], v[36:39]
    v_nop_e64
    v_mfma_f32_16x16x32_bf16 v[32:35], v[40:43], a[252:255], v[32:35]
    s_add_u32 s64, s7, s17
    buffer_load_dwordx4 v[232:235], v1, s[52:55], s64 offen offset:0 nt
    v_mov_b32 v24, 0
    v_mov_b32 v25, 1
    v_subrev_u32 v27, s66, v2
    v_lshrrev_b32 v27, 1, v27
    v_and_b32 v29, 24, v27
    v_mov_b32_e64 v28, s13
    v_add_f32_dpp v21, v21, v21 row_ror:4 row_mask:0xf bank_mask:0xf
    s_nop 0
    s_nop 0
    v_add_f32_dpp v21, v21, v21 row_ror:8 row_mask:0xf bank_mask:0xf
    v_mov_b32 v23, v21
    s_nop 1
    v_permlane16_swap_b32 v21, v23
    v_add_f32 v21, v21, v23
    v_mov_b32 v23, v21
    s_nop 1
    v_permlane32_swap_b32 v21, v23
    v_add_f32 v21, v21, v23
    v_permlane32_swap_b32 v32, v34
    v_permlane32_swap_b32 v33, v35
    v_permlane32_swap_b32 v36, v38
    v_permlane32_swap_b32 v37, v39
    v_add_f32 v32, v32, v38
    v_add_f32_e64 v33, v33, v39
    ds_write_b64 v3, v[32:33] offset:2176
    s_mov_b64 exec, 1
    ds_write_b64 v28, v[20:21] offset:4224
    ds_add_rtn_u32 v26, v24, v25 offset:4
    s_mov_b64 exec, -1
    s_nop 0
    ds_read_b64 v[30:31], v29 offset:4224
    ds_read_b64 v[40:41], v27 offset:2176
    ds_read_b64 v[42:43], v27 offset:2688
    ds_read_b64 v[44:45], v27 offset:3200
    ds_read_b64 v[46:47], v27 offset:3712
    s_add_u32 s65, s11, -185344
    s_waitcnt lgkmcnt(4)
    v_readfirstlane_b32 s15, v26
    v_max_f32_dpp v20, v30, v30 quad_perm:[1,0,3,2] row_mask:0xf bank_mask:0xf
    s_and_b32 s15, s15, 3
    s_cmp_lg_u32 s15, 3
    s_cbranch_scc1 NOTLAST_5
    v_max_f32_dpp v20, v20, v20 quad_perm:[2,3,0,1] row_mask:0xf bank_mask:0xf
    v_sub_f32 v22, v30, v20
    v_exp_f32 v22, v22
    s_nop 0
    v_mul_f32 v21, v31, v22
    s_waitcnt lgkmcnt(0)
    v_mul_f32_dpp v32, v22, v40 row_newbcast:0 row_mask:0xf bank_mask:0xf
    v_mul_f32_dpp v33, v22, v41 row_newbcast:0 row_mask:0xf bank_mask:0xf
    v_add_f32_dpp v21, v21, v21 quad_perm:[1,0,3,2] row_mask:0xf bank_mask:0xf
    v_mul_f32_dpp v34, v22, v42 row_newbcast:1 row_mask:0xf bank_mask:0xf
    v_mul_f32_dpp v35, v22, v43 row_newbcast:1 row_mask:0xf bank_mask:0xf
    v_fmac_f32_dpp v32, v22, v44 row_newbcast:2 row_mask:0xf bank_mask:0xf
    v_fmac_f32_dpp v33, v22, v45 row_newbcast:2 row_mask:0xf bank_mask:0xf
    v_add_f32_dpp v21, v21, v21 quad_perm:[2,3,0,1] row_mask:0xf bank_mask:0xf
    v_fmac_f32_dpp v34, v22, v46 row_newbcast:3 row_mask:0xf bank_mask:0xf
    v_fmac_f32_dpp v35, v22, v47 row_newbcast:3 row_mask:0xf bank_mask:0xf
    v_pk_add_f32 v[32:33], v[32:33], v[34:35]
    v_min_u32 v20, -2, v20
    v_min_u32 v21, -2, v21
    v_min_u32 v32, -2, v32
    v_min_u32_e64 v33, -2, v33
    s_add_u32 s15, s65, s14
    s_add_u32 s65, s65, s68
    s_cmp_eq_u32 s79, 0
    s_cbranch_scc0 PLOC_6
    buffer_store_dwordx2 v[32:33], v27, s[80:83], s15 offen sc1
    s_mov_b64 exec, 1
    buffer_store_dwordx2 v[20:21], v27, s[80:83], s65 offen sc1
    s_mov_b64 exec, -1
    s_branch NOTLAST_5
PLOC_6:
    buffer_store_dwordx2 v[32:33], v27, s[80:83], s15 offen
    s_mov_b64 exec, 1
    buffer_store_dwordx2 v[20:21], v27, s[80:83], s65 offen
    s_mov_b64 exec, -1
NOTLAST_5:
    s_waitcnt lgkmcnt(0)
    s_nop 0
    s_nop 0
    s_cmp_eq_u32 s6, 4
    s_cbranch_scc1 L_FIN
    s_branch L_B1
L_B0:
    s_add_u32 s65, s10, 0
    buffer_load_dwordx4 v[48:51], v19, s[80:83], s65 offen sc1
    s_waitcnt vmcnt(7)
    buffer_load_dwordx4 v2, s[48:51], s67 offen offset:1024 nt lds
    s_waitcnt vmcnt(7)
    buffer_load_dwordx4 v2, s[48:51], s67 offen offset:2048 nt lds
    s_waitcnt vmcnt(7)
    buffer_load_dwordx4 v2, s[48:51], s67 offen offset:3072 nt lds
    s_add_u32 s67, s7, s25
    s_add_u32 m0, s66, 36864
    s_waitcnt vmcnt(7)
    s_cmp_eq_u32 s9, 0
    s_cbranch_scc1 NT_7
    buffer_load_dwordx4 v2, s[48:51], s67 offen offset:0 nt lds
NT_7:
    s_add_u32 s64, s7, s16
    buffer_load_dwordx4 v[216:219], v1, s[52:55], s64 offen offset:0 nt
    s_waitcnt vmcnt(7)
    buffer_load_dwordx4 v[220:223], v1, s[52:55], s64 offen offset:1024 nt
    s_waitcnt vmcnt(7)
    buffer_load_dwordx4 v[224:227], v1, s[52:55], s64 offen offset:2048 nt
    s_waitcnt vmcnt(7)
    buffer_load_dwordx4 v[228:231], v1, s[52:55], s64 offen offset:3072 nt
    s_add_u32 s64, s7, s17
    s_waitcnt vmcnt(6)
    buffer_load_dwordx4 v[232:235], v1, s[52:55], s64 offen offset:0 nt
L_B1:
    s_add_u32 s64, s7, s17
    s_waitcnt vmcnt(6)
    buffer_load_dwordx4 v[236:239], v1, s[52:55], s64 offen offset:1024 nt
    v_max3_u32 v22, v48, v49, v50
    v_max3_u32 v22, v22, v51, v51
    v_cmp_eq_u32_e64 vcc, -1, v22
    s_cbranch_vccz QD_9
    s_add_u32 s65, s10, 0
QL_8:
    buffer_load_dwordx4 v[48:51], v19, s[80:83], s65 offen sc1
    s_waitcnt vmcnt(0)
    v_max3_u32 v22, v48, v49, v50
    v_max3_u32 v22, v22, v51, v51
    v_cmp_eq_u32 vcc, -1, v22
    s_cbranch_vccz QD_9
    s_cmp_eq_u32 s62, 0
    s_cbranch_scc1 QD_9
    s_sub_u32 s62, s62, 1
    s_branch QL_8
QD_9:
    s_nop 0
    v_cndmask_b32 v32, 0, v48, s[70:71]
    v_cndmask_b32 v33, 0, v49, s[70:71]
    v_cndmask_b32 v34, 0, v50, s[70:71]
    v_cndmask_b32 v35, 0, v51, s[70:71]
    v_cndmask_b32 v36, 0, v48, s[72:73]
    v_cndmask_b32 v37, 0, v49, s[72:73]
    v_cndmask_b32 v38, 0, v50, s[72:73]
    v_cndmask_b32 v39, 0, v51, s[72:73]
    v_cndmask_b32 v40, 0, v48, s[74:75]
    v_cndmask_b32 v41, 0, v49, s[74:75]
    v_cndmask_b32 v42, 0, v50, s[74:75]
    v_cndmask_b32 v43, 0, v51, s[74:75]
    v_cndmask_b32 v44, 0, v48, s[76:77]
    v_cndmask_b32 v45, 0, v49, s[76:77]
    v_cndmask_b32 v46, 0, v50, s[76:77]
    v_cndmask_b32 v47, 0, v51, s[76:77]
    ds_read_b128 a[204:207], v2 offset:0
    ds_read_b128 a[208:211], v2 offset:1024
    ds_read_b128 a[212:215], v2 offset:2048
    ds_read_b128 a[216:219], v2 offset:3072
    ds_read_b128 a[220:223], v2 offset:4096
    ds_read_b128 a[224:227], v2 offset:5120
    ds_read_b128 a[228:231], v2 offset:6144
    ds_read_b128 a[232:235], v2 offset:7168
    ds_read_b128 a[236:239], v2 offset:8192
    ds_read_b128 a[240:243], v2 offset:9216
    ds_read_b128 a[244:247], v2 offset:10240
    ds_read_b128 a[248:251], v2 offset:11264
    v_mfma_f32_16x16x32_bf16 v[24:27], v[68:71], v[32:35], 0
    v_mfma_f32_16x16x32_bf16 v[24:27], v[72:75], v[36:39], v[24:27]
    v_mfma_f32_16x16x32_bf16 v[24:27], v[76:79], v[40:43], v[24:27]
    v_mfma_f32_16x16x32_bf16 v[24:27], v[80:83], v[44:47], v[24:27]
    s_waitcnt vmcnt(6)
    s_nop 0
    buffer_load_dwordx4 v[240:243], v1, s[52:55], s64 offen offset:2048 nt
    v_mfma_f32_16x16x32_bf16 v[20:23], v[84:87], v[32:35], 0
    v_mfma_f32_16x16x32_bf16 v[20:23], v[88:91], v[36:39], v[20:23]
    v_mfma_f32_16x16x32_bf16 v[20:23], v[92:95], v[40:43], v[20:23]
    v_mfma_f32_16x16x32_bf16 v[20:23], v[96:99], v[44:47], v[20:23]
    v_mfma_f32_16x16x32_bf16 v[28:31], v[100:103], v[32:35], 0
    v_nop_e64
    v_mov_b32_dpp v9, v24 quad_perm:[0,0,0,0] row_mask:0xf bank_mask:0xf
    v_mfma_f32_16x16x32_bf16 v[28:31], v[104:107], v[36:39], v[28:31]
    v_nop_e64
    v_add_f32_dpp v9, v25, v9 quad_perm:[1,1,1,1] row_mask:0xf bank_mask:0xf
    v_mfma_f32_16x16x32_bf16 v[28:31], v[108:111], v[40:43], v[28:31]
    v_nop_e64
    v_add_f32_dpp v9, v26, v9 quad_perm:[2,2,2,2] row_mask:0xf bank_mask:0xf
    v_mfma_f32_16x16x32_bf16 v[28:31], v[112:115], v[44:47], v[28:31]
    v_nop_e64
    v_add_f32_dpp v9, v27, v9 quad_perm:[3,3,3,3] row_mask:0xf bank_mask:0xf
    v_mfma_f32_16x16x32_bf16 v[24:27], v[116:119], v[32:35], 0
    v_mov_b32_dpp v10, v20 quad_perm:[0,0,0,0] row_mask:0xf bank_mask:0xf
    v_mfma_f32_16x16x32_bf16 v[24:27], v[120:123], v[36:39], v[24:27]
    v_nop_e64
    v_add_f32_dpp v10, v21, v10 quad_perm:[1,1,1,1] row_mask:0xf bank_mask:0xf
    v_mfma_f32_16x16x32_bf16 v[24:27], v[124:127], v[40:43], v[24:27]
    v_nop_e64
    v_add_f32_dpp v10, v22, v10 quad_perm:[2,2,2,2] row_mask:0xf bank_mask:0xf
    v_mfma_f32_16x16x32_bf16 v[24:27], v[128:131], v[44:47], v[24:27]
    v_nop_e64
    v_add_f32_dpp v10, v23, v10 quad_perm:[3,3,3,3] row_mask:0xf bank_mask:0xf
    s_waitcnt vmcnt(6)
    buffer_load_dwordx4 v[244:247], v1, s[52:55], s64 offen offset:3072 nt
    v_mfma_f32_16x16x32_bf16 v[20:23], v[132:135], v[32:35], 0
    v_mov_b32_dpp v11, v28 quad_perm:[0,0,0,0] row_mask:0xf bank_mask:0xf
    v_mfma_f32_16x16x32_bf16 v[20:23], v[136:139], v[36:39], v[20:23]
    s_nop 0
    v_add_f32_dpp v11, v29, v11 quad_perm:[1,1,1,1] row_mask:0xf bank_mask:0xf
    v_mfma_f32_16x16x32_bf16 v[20:23], v[140:143], v[40:43], v[20:23]
    v_nop_e64
    v_add_f32_dpp v11, v30, v11 quad_perm:[2,2,2,2] row_mask:0xf bank_mask:0xf
    v_mfma_f32_16x16x32_bf16 v[20:23], v[144:147], v[44:47], v[20:23]
    v_nop_e64
    v_add_f32_dpp v11, v31, v11 quad_perm:[3,3,3,3] row_mask:0xf bank_mask:0xf
    v_mfma_f32_16x16x32_bf16 v[28:31], v[148:151], v[32:35], 0
    v_mov_b32_dpp v12, v24 quad_perm:[0,0,0,0] row_mask:0xf bank_mask:0xf
    v_mfma_f32_16x16x32_bf16 v[28:31], v[152:155], v[36:39], v[28:31]
    v_nop_e64
    v_add_f32_dpp v12, v25, v12 quad_perm:[1,1,1,1] row_mask:0xf bank_mask:0xf
    v_mfma_f32_16x16x32_bf16 v[28:31], v[156:159], v[40:43], v[28:31]
    v_nop_e64
    v_add_f32_dpp v12, v26, v12 quad_perm:[2,2,2,2] row_mask:0xf bank_mask:0xf
    v_mfma_f32_16x16x32_bf16 v[28:31], v[160:163], v[44:47], v[28:31]
    v_nop_e64
    v_add_f32_dpp v12, v27, v12 quad_perm:[3,3,3,3] row_mask:0xf bank_mask:0xf
    v_mfma_f32_16x16x32_bf16 v[24:27], v[164:167], v[32:35], 0
    v_mov_b32_dpp v13, v20 quad_perm:[0,0,0,0] row_mask:0xf bank_mask:0xf
    v_mfma_f32_16x16x32_bf16 v[24:27], v[168:171], v[36:39], v[24:27]
    v_nop_e64
    v_add_f32_dpp v13, v21, v13 quad_perm:[1,1,1,1] row_mask:0xf bank_mask:0xf
    v_mfma_f32_16x16x32_bf16 v[24:27], v[172:175], v[40:43], v[24:27]
    v_nop_e64
    v_add_f32_dpp v13, v22, v13 quad_perm:[2,2,2,2] row_mask:0xf bank_mask:0xf
    v_mfma_f32_16x16x32_bf16 v[24:27], v[176:179], v[44:47], v[24:27]
    v_nop_e64
    v_add_f32_dpp v13, v23, v13 quad_perm:[3,3,3,3] row_mask:0xf bank_mask:0xf
    s_add_u32 s64, s7, s18
    s_waitcnt vmcnt(6)
    buffer_load_dwordx4 v[248:251], v1, s[52:55], s64 offen offset:0 nt
    v_mfma_f32_16x16x32_bf16 v[20:23], v[180:183], v[32:35], 0
    v_mov_b32_dpp v14, v28 quad_perm:[0,0,0,0] row_mask:0xf bank_mask:0xf
    v_mfma_f32_16x16x32_bf16 v[20:23], v[184:187], v[36:39], v[20:23]
    v_nop_e64
    v_add_f32_dpp v14, v29, v14 quad_perm:[1,1,1,1] row_mask:0xf bank_mask:0xf
    v_mfma_f32_16x16x32_bf16 v[20:23], v[188:191], v[40:43], v[20:23]
    v_nop_e64
    v_add_f32_dpp v14, v30, v14 quad_perm:[2,2,2,2] row_mask:0xf bank_mask:0xf
    v_mfma_f32_16x16x32_bf16 v[20:23], v[192:195], v[44:47], v[20:23]
    v_nop_e64
    v_add_f32_dpp v14, v31, v14 quad_perm:[3,3,3,3] row_mask:0xf bank_mask:0xf
    v_mfma_f32_16x16x32_bf16 v[28:31], v[196:199], v[32:35], 0
    v_mov_b32_dpp v15, v24 quad_perm:[0,0,0,0] row_mask:0xf bank_mask:0xf
    v_mfma_f32_16x16x32_bf16 v[28:31], v[200:203], v[36:39], v[28:31]
    v_nop_e64
    v_add_f32_dpp v15, v25, v15 quad_perm:[1,1,1,1] row_mask:0xf bank_mask:0xf
    v_mfma_f32_16x16x32_bf16 v[28:31], v[204:207], v[40:43], v[28:31]
    v_nop_e64
    v_add_f32_dpp v15, v26, v15 quad_perm:[2,2,2,2] row_mask:0xf bank_mask:0xf
    v_mfma_f32_16x16x32_bf16 v[28:31], v[208:211], v[44:47], v[28:31]
    v_nop_e64
    v_add_f32_dpp v15, v27, v15 quad_perm:[3,3,3,3] row_mask:0xf bank_mask:0xf
    v_mfma_f32_16x16x32_bf16 v[24:27], v[212:215], v[32:35], 0
    v_mov_b32_dpp v16, v20 quad_perm:[0,0,0,0] row_mask:0xf bank_mask:0xf
    s_nop 0
    s_nop 0
    v_add_f32_dpp v16, v21, v16 quad_perm:[1,1,1,1] row_mask:0xf bank_mask:0xf
    s_nop 0
    s_nop 0
    v_add_f32_dpp v16, v22, v16 quad_perm:[2,2,2,2] row_mask:0xf bank_mask:0xf
    s_nop 0
    s_nop 0
    v_add_f32_dpp v16, v23, v16 quad_perm:[3,3,3,3] row_mask:0xf bank_mask:0xf
    s_waitcnt vmcnt(6)
    buffer_load_dwordx4 v[252:255], v1, s[52:55], s64 offen offset:1024 nt
    v_mov_b32_dpp v17, v28 quad_perm:[0,0,0,0] row_mask:0xf bank_mask:0xf
    v_add_f32_dpp v18, v24, v8 quad_perm:[0,0,0,0] row_mask:0xf bank_mask:0xf
    s_nop 0
    v_add_f32_dpp v17, v29, v17 quad_perm:[1,1,1,1] row_mask:0xf bank_mask:0xf
    v_add_f32_dpp v18, v25, v18 quad_perm:[1,1,1,1] row_mask:0xf bank_mask:0xf
    v_nop_e64
    v_add_f32_dpp v17, v30, v17 quad_perm:[2,2,2,2] row_mask:0xf bank_mask:0xf
    v_add_f32_dpp v18, v26, v18 quad_perm:[2,2,2,2] row_mask:0xf bank_mask:0xf
    v_nop_e64
    v_add_f32_dpp v17, v31, v17 quad_perm:[3,3,3,3] row_mask:0xf bank_mask:0xf
    v_add_f32_dpp v18, v27, v18 quad_perm:[3,3,3,3] row_mask:0xf bank_mask:0xf
    v_max3_f32 v20, v9, v10, v11
    v_max3_f32 v21, v12, v13, v14
    v_max3_f32 v20, v20, v15, v16
    v_max3_f32 v21, v21, v17, v18
    v_max_f32 v20, v20, v21
    s_nop 1
    v_max_f32_dpp v20, v20, v20 row_ror:4 row_mask:0xf bank_mask:0xf
    s_nop 0
    s_nop 0
    v_max_f32_dpp v20, v20, v20 row_ror:8 row_mask:0xf bank_mask:0xf
    v_mov_b32 v23, v20
    s_nop 1
    v_permlane16_swap_b32 v20, v23
    v_max_f32 v20, v20, v23
    v_mov_b32 v23, v20
    s_nop 1
    v_permlane32_swap_b32 v20, v23
    v_max_f32 v20, v20, v23
    v_mul_f32_e64 v20, s63, v20
    v_fma_f32 v9, v9, s63, -v20
    v_fma_f32 v10, v10, s63, -v20
    v_fma_f32 v11, v11, s63, -v20
    v_fma_f32 v12, v12, s63, -v20
    v_fma_f32 v13, v13, s63, -v20
    v_fma_f32 v14, v14, s63, -v20
    v_fma_f32 v15, v15, s63, -v20
    v_fma_f32 v16, v16, s63, -v20
    v_fma_f32 v17, v17, s63, -v20
    v_fma_f32 v18, v18, s63, -v20
    v_exp_f32 v9, v9
    v_exp_f32 v10, v10
    v_exp_f32 v11, v11
    v_exp_f32 v12, v12
    v_exp_f32 v13, v13
    v_exp_f32 v14, v14
    v_exp_f32 v15, v15
    v_exp_f32 v16, v16
    v_exp_f32 v17, v17
    v_exp_f32 v18, v18
    v_add_f32 v21, v9, v10
    v_add_f32 v21, v21, v11
    v_add_f32 v21, v21, v12
    v_add_f32 v21, v21, v13
    v_add_f32 v21, v21, v14
    v_add_f32 v21, v21, v15
    v_add_f32 v21, v21, v16
    v_add_f32 v21, v21, v17
    v_add_f32_e64 v21, v21, v18
    v_cvt_pk_bf16_f32 v9, v9, v9
    v_cvt_pk_bf16_f32 v10, v10, v10
    v_cvt_pk_bf16_f32 v11, v11, v11
    v_cvt_pk_bf16_f32 v12, v12, v12
    v_cvt_pk_bf16_f32 v13, v13, v13
    v_cvt_pk_bf16_f32 v14, v14, v14
    v_cvt_pk_bf16_f32 v15, v15, v15
    v_cvt_pk_bf16_f32 v16, v16, v16
    v_cvt_pk_bf16_f32 v17, v17, v17
    v_cvt_pk_bf16_f32 v18, v18, v18
    s_waitcnt vmcnt(6)
    buffer_load_dwordx4 a[0:3], v1, s[52:55], s64 offen offset:2048 nt
    v_and_b32 v40, v9, v4
    v_and_b32_e64 v41, v9, v5
    v_and_b32_dpp v42, v9, v6 row_ror:4 row_mask:0xf bank_mask:0xf
    v_and_b32_dpp v43, v9, v7 row_ror:4 row_mask:0xf bank_mask:0xf
    v_and_b32_dpp v44, v9, v4 row_ror:12 row_mask:0xf bank_mask:0xf
    v_and_b32_dpp v45, v9, v5 row_ror:12 row_mask:0xf bank_mask:0xf
    s_waitcnt lgkmcnt(8)
    v_mfma_f32_16x16x32_bf16 v[32:35], v[40:43], a[204:207], 0
    v_and_b32 v46, v9, v6
    v_and_b32_e64 v47, v9, v7
    v_mfma_f32_16x16x32_bf16 v[36:39], v[40:43], a[212:215], 0
    v_and_b32 v40, v10, v4
    v_and_b32 v41, v10, v5
    v_mfma_f32_16x16x32_bf16 v[32:35], v[44:47], a[208:211], v[32:35]
    v_and_b32_dpp v42, v10, v6 row_ror:4 row_mask:0xf bank_mask:0xf
    v_and_b32_dpp v43, v10, v7 row_ror:4 row_mask:0xf bank_mask:0xf
    v_mfma_f32_16x16x32_bf16 v[36:39], v[44:47], a[216:219], v[36:39]
    ds_read_b128 a[204:207], v2 offset:12288
    ds_read_b128 a[208:211], v2 offset:13312
    ds_read_b128 a[212:215], v2 offset:14336
    ds_read_b128 a[216:219], v2 offset:15360
    v_and_b32_dpp v44, v10, v4 row_ror:12 row_mask:0xf bank_mask:0xf
    v_and_b32_dpp v45, v10, v5 row_ror:12 row_mask:0xf bank_mask:0xf
    s_waitcnt lgkmcnt(8)
    v_mfma_f32_16x16x32_bf16 v[32:35], v[40:43], a[220:223], v[32:35]
    v_and_b32 v46, v10, v6
    v_and_b32_e64 v47, v10, v7
    v_mfma_f32_16x16x32_bf16 v[36:39], v[40:43], a[228:231], v[36:39]
    v_and_b32 v40, v11, v4
    v_and_b32 v41, v11, v5
    v_mfma_f32_16x16x32_bf16 v[32:35], v[44:47], a[224:227], v[32:35]
    v_and_b32_dpp v42, v11, v6 row_ror:4 row_mask:0xf bank_mask:0xf
    v_and_b32_dpp v43, v11, v7 row_ror:4 row_mask:0xf bank_mask:0xf
    v_mfma_f32_16x16x32_bf16 v[36:39], v[44:47], a[232:235], v[36:39]
    ds_read_b128 a[220:223], v2 offset:16384
    ds_read_b128 a[224:227], v2 offset:17408
    ds_read_b128 a[228:231], v2 offset:18432
    ds_read_b128 a[232:235], v2 offset:19456
    v_and_b32_dpp v44, v11, v4 row_ror:12 row_mask:0xf bank_mask:0xf
    v_and_b32_dpp v45, v11, v5 row_ror:12 row_mask:0xf bank_mask:0xf
    s_waitcnt lgkmcnt(8)
    v_mfma_f32_16x16x32_bf16 v[32:35], v[40:43], a[236:239], v[32:35]
    v_and_b32 v46, v11, v6
    v_and_b32_e64 v47, v11, v7
    v_mfma_f32_16x16x32_bf16 v[36:39], v[40:43], a[244:247], v[36:39]
    v_and_b32 v40, v12, v4
    v_and_b32 v41, v12, v5
    v_mfma_f32_16x16x32_bf16 v[32:35], v[44:47], a[240:243], v[32:35]
    v_and_b32_dpp v42, v12, v6 row_ror:4 row_mask:0xf bank_mask:0xf
    v_and_b32_dpp v43, v12, v7 row_ror:4 row_mask:0xf bank_mask:0xf
    v_mfma_f32_16x16x32_bf16 v[36:39], v[44:47], a[248:251], v[36:39]
    ds_read_b128 a[236:239], v2 offset:20480
    ds_read_b128 a[240:243], v2 offset:21504
    ds_read_b128 a[244:247], v2 offset:22528
    ds_read_b128 a[248:251], v2 offset:23552
    s_waitcnt vmcnt(6)
    buffer_load_dwordx4 a[4:7], v1, s[52:55], s64 offen offset:3072 nt
    v_and_b32_dpp v44, v12, v4 row_ror:12 row_mask:0xf bank_mask:0xf
    v_and_b32_dpp v45, v12, v5 row_ror:12 row_mask:0xf bank_mask:0xf
    s_waitcnt lgkmcnt(8)
    v_mfma_f32_16x16x32_bf16 v[32:35], v[40:43], a[204:207], v[32:35]
    v_and_b32 v46, v12, v6
    v_and_b32 v47, v12, v7
    v_mfma_f32_16x16x32_bf16 v[36:39], v[40:43], a[212:215], v[36:39]
    v_and_b32 v40, v13, v4
    v_and_b32 v41, v13, v5
    v_mfma_f32_16x16x32_bf16 v[32:35], v[44:47], a[208:211], v[32:35]
    v_and_b32_dpp v42, v13, v6 row_ror:4 row_mask:0xf bank_mask:0xf
    v_and_b32_dpp v43, v13, v7 row_ror:4 row_mask:0xf bank_mask:0xf
    v_mfma_f32_16x16x32_bf16 v[36:39], v[44:47], a[216:219], v[36:39]
    ds_read_b128 a[204:207], v2 offset:24576
    ds_read_b128 a[208:211], v2 offset:25600
    ds_read_b128 a[212:215], v2 offset:26624
    ds_read_b128 a[216:219], v2 offset:27648
    v_and_b32_dpp v44, v13, v4 row_ror:12 row_mask:0xf bank_mask:0xf
    v_and_b32_dpp v45, v13, v5 row_ror:12 row_mask:0xf bank_mask:0xf
    s_waitcnt lgkmcnt(8)
    v_mfma_f32_16x16x32_bf16 v[32:35], v[40:43], a[220:223], v[32:35]
    v_and_b32 v46, v13, v6
    v_and_b32_e64 v47, v13, v7
    v_mfma_f32_16x16x32_bf16 v[36:39], v[40:43], a[228:231], v[36:39]
    v_and_b32 v40, v14, v4
    v_and_b32 v41, v14, v5
    v_mfma_f32_16x16x32_bf16 v[32:35], v[44:47], a[224:227], v[32:35]
    v_and_b32_dpp v42, v14, v6 row_ror:4 row_mask:0xf bank_mask:0xf
    v_and_b32_dpp v43, v14, v7 row_ror:4 row_mask:0xf bank_mask:0xf
    v_mfma_f32_16x16x32_bf16 v[36:39], v[44:47], a[232:235], v[36:39]
    ds_read_b128 a[220:223], v2 offset:28672
    ds_read_b128 a[224:227], v2 offset:29696
    ds_read_b128 a[228:231], v2 offset:30720
    ds_read_b128 a[232:235], v2 offset:31744
    v_and_b32_dpp v44, v14, v4 row_ror:12 row_mask:0xf bank_mask:0xf
    v_and_b32_dpp v45, v14, v5 row_ror:12 row_mask:0xf bank_mask:0xf
    s_waitcnt lgkmcnt(8)
    v_mfma_f32_16x16x32_bf16 v[32:35], v[40:43], a[236:239], v[32:35]
    v_and_b32 v46, v14, v6
    v_and_b32_e64 v47, v14, v7
    v_mfma_f32_16x16x32_bf16 v[36:39], v[40:43], a[244:247], v[36:39]
    v_and_b32 v40, v15, v4
    v_and_b32 v41, v15, v5
    v_mfma_f32_16x16x32_bf16 v[32:35], v[44:47], a[240:243], v[32:35]
    v_and_b32_dpp v42, v15, v6 row_ror:4 row_mask:0xf bank_mask:0xf
    v_and_b32_dpp v43, v15, v7 row_ror:4 row_mask:0xf bank_mask:0xf
    v_mfma_f32_16x16x32_bf16 v[36:39], v[44:47], a[248:251], v[36:39]
    ds_read_b128 a[236:239], v2 offset:32768
    ds_read_b128 a[240:243], v2 offset:33792
    ds_read_b128 a[244:247], v2 offset:34816
    ds_read_b128 a[248:251], v2 offset:35840
    s_add_u32 s64, s7, s19
    s_waitcnt vmcnt(6)
    buffer_load_dwordx4 a[8:11], v1, s[52:55], s64 offen offset:0 nt
    v_and_b32_dpp v44, v15, v4 row_ror:12 row_mask:0xf bank_mask:0xf
    v_and_b32_dpp v45, v15, v5 row_ror:12 row_mask:0xf bank_mask:0xf
    s_waitcnt lgkmcnt(8)
    v_mfma_f32_16x16x32_bf16 v[32:35], v[40:43], a[204:207], v[32:35]
    v_and_b32 v46, v15, v6
    v_and_b32_e64 v47, v15, v7
    v_mfma_f32_16x16x32_bf16 v[36:39], v[40:43], a[212:215], v[36:39]
    v_and_b32 v40, v16, v4
    v_and_b32 v41, v16, v5
    v_mfma_f32_16x16x32_bf16 v[32:35], v[44:47], a[208:211], v[32:35]
    v_and_b32_dpp v42, v16, v6 row_ror:4 row_mask:0xf bank_mask:0xf
    v_and_b32_dpp v43, v16, v7 row_ror:4 row_mask:0xf bank_mask:0xf
    v_mfma_f32_16x16x32_bf16 v[36:39], v[44:47], a[216:219], v[36:39]
    ds_read_b128 a[204:207], v2 offset:36864
    v_and_b32_dpp v44, v16, v4 row_ror:12 row_mask:0xf bank_mask:0xf
    v_and_b32_dpp v45, v16, v5 row_ror:12 row_mask:0xf bank_mask:0xf
    s_waitcnt lgkmcnt(5)
    v_mfma_f32_16x16x32_bf16 v[32:35], v[40:43], a[220:223], v[32:35]
    v_and_b32 v46, v16, v6
    v_and_b32_e64 v47, v16, v7
    v_mfma_f32_16x16x32_bf16 v[36:39], v[40:43], a[228:231], v[36:39]
    v_and_b32 v40, v17, v4
    v_and_b32 v41, v17, v5
    v_mfma_f32_16x16x32_bf16 v[32:35], v[44:47], a[224:227], v[32:35]
    v_and_b32_dpp v42, v17, v6 row_ror:4 row_mask:0xf bank_mask:0xf
    v_and_b32_dpp v43, v17, v7 row_ror:4 row_mask:0xf bank_mask:0xf
    v_mfma_f32_16x16x32_bf16 v[36:39], v[44:47], a[232:235], v[36:39]
    v_and_b32_dpp v44, v17, v4 row_ror:12 row_mask:0xf bank_mask:0xf
    v_and_b32_dpp v45, v17, v5 row_ror:12 row_mask:0xf bank_mask:0xf
    s_waitcnt lgkmcnt(1)
    v_mfma_f32_16x16x32_bf16 v[32:35], v[40:43], a[236:239], v[32:35]
    v_and_b32 v46, v17, v6
    v_and_b32_e64 v47, v17, v7
    v_mfma_f32_16x16x32_bf16 v[36:39], v[40:43], a[244:247], v[36:39]
    v_and_b32 v40, v18, v4
    v_and_b32 v41, v18, v5
    v_mfma_f32_16x16x32_bf16 v[32:35], v[44:47], a[240:243], v[32:35]
    v_and_b32_dpp v42, v18, v6 row_ror:4 row_mask:0xf bank_mask:0xf
    v_and_b32_dpp v43, v18, v7 row_ror:4 row_mask:0xf bank_mask:0xf
    v_mfma_f32_16x16x32_bf16 v[36:39], v[44:47], a[248:251], v[36:39]
    s_waitcnt vmcnt(6)
    buffer_load_dwordx4 a[12:15], v1, s[52:55], s64 offen offset:1024 nt
    s_waitcnt lgkmcnt(0)
    v_mfma_f32_16x16x32_bf16 v[32:35], v[40:43], a[204:207], v[32:35]
    v_mov_b32 v24, 0
    v_mov_b32 v25, 1
    v_subrev_u32 v27, s66, v2
    v_lshrrev_b32 v27, 1, v27
    v_and_b32 v29, 24, v27
    v_mov_b32 v28, s13
    v_add_f32_dpp v21, v21, v21 row_ror:4 row_mask:0xf bank_mask:0xf
    s_nop 0
    s_nop 0
    v_add_f32_dpp v21, v21, v21 row_ror:8 row_mask:0xf bank_mask:0xf
    v_mov_b32 v23, v21
    s_nop 1
    v_permlane16_swap_b32 v21, v23
    v_add_f32 v21, v21, v23
    v_mov_b32 v23, v21
    s_nop 1
    v_permlane32_swap_b32 v21, v23
    v_add_f32 v21, v21, v23
    v_permlane32_swap_b32 v32, v34
    v_permlane32_swap_b32 v33, v35
    v_permlane32_swap_b32 v36, v38
    v_permlane32_swap_b32 v37, v39
    v_add_f32 v32, v32, v38
    v_add_f32_e64 v33, v33, v39
    ds_write_b64 v3, v[32:33] offset:64
    s_mov_b64 exec, 1
    ds_write_b64 v28, v[20:21] offset:2112
    ds_add_rtn_u32 v26, v24, v25 offset:0
    s_mov_b64 exec, -1
    s_nop 0
    ds_read_b64 v[30:31], v29 offset:2112
    ds_read_b64 v[40:41], v27 offset:64
    ds_read_b64 v[42:43], v27 offset:576
    ds_read_b64 v[44:45], v27 offset:1088
    ds_read_b64 v[46:47], v27 offset:1600
    s_add_u32 s65, s11, 0
    s_waitcnt lgkmcnt(4)
    v_readfirstlane_b32 s15, v26
    v_max_f32_dpp v20, v30, v30 quad_perm:[1,0,3,2] row_mask:0xf bank_mask:0xf
    s_and_b32 s15, s15, 3
    s_cmp_lg_u32 s15, 3
    s_cbranch_scc1 NOTLAST_10
    v_max_f32_dpp v20, v20, v20 quad_perm:[2,3,0,1] row_mask:0xf bank_mask:0xf
    v_sub_f32 v22, v30, v20
    v_exp_f32 v22, v22
    v_nop_e64
    v_mul_f32 v21, v31, v22
    s_waitcnt lgkmcnt(0)
    v_mul_f32_dpp v32, v22, v40 row_newbcast:0 row_mask:0xf bank_mask:0xf
    v_mul_f32_dpp v33, v22, v41 row_newbcast:0 row_mask:0xf bank_mask:0xf
    v_add_f32_dpp v21, v21, v21 quad_perm:[1,0,3,2] row_mask:0xf bank_mask:0xf
    v_mul_f32_dpp v34, v22, v42 row_newbcast:1 row_mask:0xf bank_mask:0xf
    v_mul_f32_dpp v35, v22, v43 row_newbcast:1 row_mask:0xf bank_mask:0xf
    v_fmac_f32_dpp v32, v22, v44 row_newbcast:2 row_mask:0xf bank_mask:0xf
    v_fmac_f32_dpp v33, v22, v45 row_newbcast:2 row_mask:0xf bank_mask:0xf
    v_add_f32_dpp v21, v21, v21 quad_perm:[2,3,0,1] row_mask:0xf bank_mask:0xf
    v_fmac_f32_dpp v34, v22, v46 row_newbcast:3 row_mask:0xf bank_mask:0xf
    v_fmac_f32_dpp v35, v22, v47 row_newbcast:3 row_mask:0xf bank_mask:0xf
    v_pk_add_f32 v[32:33], v[32:33], v[34:35]
    v_min_u32 v20, -2, v20
    v_min_u32 v21, -2, v21
    v_min_u32 v32, -2, v32
    v_min_u32_e64 v33, -2, v33
    s_add_u32 s15, s65, s14
    s_add_u32 s65, s65, s68
    s_cmp_eq_u32 s79, 0
    s_cbranch_scc0 PLOC_11
    buffer_store_dwordx2 v[32:33], v27, s[80:83], s15 offen sc1
    s_mov_b64 exec, 1
    buffer_store_dwordx2 v[20:21], v27, s[80:83], s65 offen sc1
    s_mov_b64 exec, -1
    s_branch NOTLAST_10
PLOC_11:
    buffer_store_dwordx2 v[32:33], v27, s[80:83], s15 offen
    s_mov_b64 exec, 1
    buffer_store_dwordx2 v[20:21], v27, s[80:83], s65 offen
    s_mov_b64 exec, -1
NOTLAST_10:
    s_waitcnt lgkmcnt(0)
    s_nop 1
    s_add_u32 s8, s7, 0x2000000
    s_cmp_lt_u32 s6, 3
    s_cselect_b32 s46, s60, 0
    s_cselect_b32 s50, s61, 0
    s_waitcnt vmcnt(6)
    buffer_load_dwordx4 a[16:19], v1, s[52:55], s64 offen offset:2048 nt
    s_waitcnt vmcnt(6)
    buffer_load_dwordx4 a[20:23], v1, s[52:55], s64 offen offset:3072 nt
    s_add_u32 s64, s7, s20
    s_waitcnt vmcnt(6)
    buffer_load_dwordx4 a[24:27], v1, s[52:55], s64 offen offset:0 nt
    s_waitcnt vmcnt(6)
    buffer_load_dwordx4 a[28:31], v1, s[52:55], s64 offen offset:1024 nt
    s_waitcnt vmcnt(6)
    buffer_load_dwordx4 a[32:35], v1, s[52:55], s64 offen offset:2048 nt
    s_waitcnt vmcnt(6)
    buffer_load_dwordx4 a[36:39], v1, s[52:55], s64 offen offset:3072 nt
    s_add_u32 s64, s7, s21
    s_waitcnt vmcnt(6)
    buffer_load_dwordx4 a[40:43], v1, s[52:55], s64 offen offset:0 nt
    s_waitcnt vmcnt(6)
    buffer_load_dwordx4 a[44:47], v1, s[52:55], s64 offen offset:1024 nt
    s_waitcnt vmcnt(6)
    buffer_load_dwordx4 a[48:51], v1, s[52:55], s64 offen offset:2048 nt
    s_waitcnt vmcnt(6)
    buffer_load_dwordx4 a[52:55], v1, s[52:55], s64 offen offset:3072 nt
    s_add_u32 s64, s7, s22
    s_waitcnt vmcnt(6)
    buffer_load_dwordx4 a[56:59], v1, s[52:55], s64 offen offset:0 nt
    s_waitcnt vmcnt(6)
    buffer_load_dwordx4 a[60:63], v1, s[52:55], s64 offen offset:1024 nt
    s_waitcnt vmcnt(6)
    buffer_load_dwordx4 a[64:67], v1, s[52:55], s64 offen offset:2048 nt
    s_waitcnt vmcnt(6)
    buffer_load_dwordx4 a[68:71], v1, s[52:55], s64 offen offset:3072 nt
    s_add_u32 s64, s7, s23
    s_waitcnt vmcnt(6)
    buffer_load_dwordx4 a[72:75], v1, s[52:55], s64 offen offset:0 nt
    s_waitcnt vmcnt(6)
    buffer_load_dwordx4 a[76:79], v1, s[52:55], s64 offen offset:1024 nt
    s_waitcnt vmcnt(6)
    buffer_load_dwordx4 a[80:83], v1, s[52:55], s64 offen offset:2048 nt
    s_waitcnt vmcnt(6)
    buffer_load_dwordx4 a[84:87], v1, s[52:55], s64 offen offset:3072 nt
    s_add_u32 s64, s7, s24
    s_waitcnt vmcnt(6)
    buffer_load_dwordx4 a[88:91], v1, s[52:55], s64 offen offset:0 nt
    s_waitcnt vmcnt(6)
    buffer_load_dwordx4 a[92:95], v1, s[52:55], s64 offen offset:1024 nt
    s_waitcnt vmcnt(6)
    buffer_load_dwordx4 a[96:99], v1, s[52:55], s64 offen offset:2048 nt
    s_waitcnt vmcnt(6)
    buffer_load_dwordx4 a[100:103], v1, s[52:55], s64 offen offset:3072 nt
    s_add_u32 s64, s7, s25
    s_waitcnt vmcnt(6)
    s_cmp_eq_u32 s9, 0
    s_cbranch_scc1 NT_12
    buffer_load_dwordx4 a[104:107], v1, s[52:55], s64 offen offset:0 nt
NT_12:
    s_add_u32 s26, s8, 13312
    s_add_u32 s27, s8, 33792
    s_mov_b32 s28, 0
    s_add_u32 s15, s10, 185344
    v_mov_b32 v52, -1
    v_mov_b32 v53, -1
    v_mov_b32_e64 v54, -1
    v_mov_b32 v55, -1
    s_add_u32 s67, s7, s16
    buffer_load_dwordx4 a[108:111], v2, s[56:59], s67 offen offset:0 nt
    s_waitcnt vmcnt(6)
    buffer_load_dwordx4 a[112:115], v2, s[56:59], s67 offen offset:1024 nt
    s_waitcnt vmcnt(6)
    buffer_load_dwordx4 a[116:119], v2, s[56:59], s67 offen offset:2048 nt
    s_waitcnt vmcnt(6)
    buffer_load_dwordx4 a[120:123], v2, s[56:59], s67 offen offset:3072 nt
    buffer_load_dwordx4 v[52:55], v19, s[80:83], s15 offen sc1
    s_add_u32 s67, s7, s17
    s_waitcnt vmcnt(7)
    buffer_load_dwordx4 a[124:127], v2, s[56:59], s67 offen offset:0 nt
    s_waitcnt vmcnt(7)
    buffer_load_dwordx4 a[128:131], v2, s[56:59], s67 offen offset:1024 nt
    s_waitcnt vmcnt(7)
    buffer_load_dwordx4 a[132:135], v2, s[56:59], s67 offen offset:2048 nt
    s_waitcnt vmcnt(7)
    buffer_load_dwordx4 a[136:139], v2, s[56:59], s67 offen offset:3072 nt
    v_max3_u32 v22, v52, v53, v54
    v_max3_u32 v22, v22, v55, v55
    v_cmp_eq_u32 vcc, -1, v22
    s_cbranch_vccz L_TB2
    buffer_load_dwordx4 v[52:55], v19, s[80:83], s15 offen sc1
    s_add_u32 s67, s7, s18
    s_waitcnt vmcnt(8)
    buffer_load_dwordx4 a[140:143], v2, s[56:59], s67 offen offset:0 nt
    s_waitcnt vmcnt(8)
    buffer_load_dwordx4 a[144:147], v2, s[56:59], s67 offen offset:1024 nt
    s_waitcnt vmcnt(8)
    buffer_load_dwordx4 a[148:151], v2, s[56:59], s67 offen offset:2048 nt
    s_waitcnt vmcnt(7)
    buffer_load_dwordx4 a[152:155], v2, s[56:59], s67 offen offset:3072 nt
    v_max3_u32 v22, v52, v53, v54
    v_max3_u32 v22, v22, v55, v55
    v_cmp_eq_u32 vcc, -1, v22
    s_cbranch_vccz L_TB3
    buffer_load_dwordx4 v[52:55], v19, s[80:83], s15 offen sc1
    s_add_u32 s67, s7, s19
    s_waitcnt vmcnt(8)
    buffer_load_dwordx4 a[156:159], v2, s[56:59], s67 offen offset:0 nt
    s_waitcnt vmcnt(8)
    buffer_load_dwordx4 a[160:163], v2, s[56:59], s67 offen offset:1024 nt
    s_waitcnt vmcnt(8)
    buffer_load_dwordx4 a[164:167], v2, s[56:59], s67 offen offset:2048 nt
    s_waitcnt vmcnt(7)
    buffer_load_dwordx4 a[168:171], v2, s[56:59], s67 offen offset:3072 nt
    v_max3_u32 v22, v52, v53, v54
    v_max3_u32 v22, v22, v55, v55
    v_cmp_eq_u32 vcc, -1, v22
    s_cbranch_vccz L_TB4
    buffer_load_dwordx4 v[52:55], v19, s[80:83], s15 offen sc1
    s_add_u32 s67, s7, s20
    s_waitcnt vmcnt(8)
    buffer_load_dwordx4 a[172:175], v2, s[56:59], s67 offen offset:0 nt
    s_waitcnt vmcnt(8)
    buffer_load_dwordx4 a[176:179], v2, s[56:59], s67 offen offset:1024 nt
    s_waitcnt vmcnt(8)
    buffer_load_dwordx4 a[180:183], v2, s[56:59], s67 offen offset:2048 nt
    s_waitcnt vmcnt(7)
    buffer_load_dwordx4 a[184:187], v2, s[56:59], s67 offen offset:3072 nt
    v_max3_u32 v22, v52, v53, v54
    v_max3_u32 v22, v22, v55, v55
    v_cmp_eq_u32 vcc, -1, v22
    s_cbranch_vccz L_TB5
    buffer_load_dwordx4 v[52:55], v19, s[80:83], s15 offen sc1
    s_add_u32 s67, s7, s21
    s_waitcnt vmcnt(8)
    buffer_load_dwordx4 a[188:191], v2, s[56:59], s67 offen offset:0 nt
    s_waitcnt vmcnt(8)
    buffer_load_dwordx4 a[192:195], v2, s[56:59], s67 offen offset:1024 nt
    s_waitcnt vmcnt(8)
    buffer_load_dwordx4 a[196:199], v2, s[56:59], s67 offen offset:2048 nt
    s_waitcnt vmcnt(7)
    buffer_load_dwordx4 a[200:203], v2, s[56:59], s67 offen offset:3072 nt
    v_max3_u32 v22, v52, v53, v54
    v_max3_u32 v22, v22, v55, v55
    v_cmp_eq_u32 vcc, -1, v22
    s_cbranch_vccz L_TB6
    s_add_u32 s67, s7, s22
    s_waitcnt vmcnt(7)
    buffer_load_dwordx4 a[204:207], v2, s[56:59], s67 offen offset:0 nt
    s_waitcnt vmcnt(7)
    buffer_load_dwordx4 a[208:211], v2, s[56:59], s67 offen offset:1024 nt
    s_waitcnt vmcnt(7)
    buffer_load_dwordx4 a[212:215], v2, s[56:59], s67 offen offset:2048 nt
    buffer_load_dwordx4 v[52:55], v19, s[80:83], s15 offen sc1
    s_waitcnt vmcnt(7)
    buffer_load_dwordx4 a[216:219], v2, s[56:59], s67 offen offset:3072 nt
    s_add_u32 s67, s7, s23
    s_waitcnt vmcnt(7)
    buffer_load_dwordx4 a[220:223], v2, s[56:59], s67 offen offset:0 nt
    s_waitcnt vmcnt(7)
    buffer_load_dwordx4 a[224:227], v2, s[56:59], s67 offen offset:1024 nt
    s_waitcnt vmcnt(7)
    buffer_load_dwordx4 a[228:231], v2, s[56:59], s67 offen offset:2048 nt
    s_waitcnt vmcnt(7)
    buffer_load_dwordx4 a[232:235], v2, s[56:59], s67 offen offset:3072 nt
    s_add_u32 s67, s7, s24
    s_waitcnt vmcnt(7)
    buffer_load_dwordx4 a[236:239], v2, s[56:59], s67 offen offset:0 nt
    s_waitcnt vmcnt(7)
    buffer_load_dwordx4 a[240:243], v2, s[56:59], s67 offen offset:1024 nt
    s_waitcnt vmcnt(7)
    v_max3_u32 v22, v52, v53, v54
    v_max3_u32 v22, v22, v55, v55
    v_cmp_eq_u32_e64 vcc, -1, v22
    s_cbranch_vccz L_Q2D
    s_waitcnt vmcnt(6)
    buffer_load_dwordx4 a[244:247], v2, s[56:59], s67 offen offset:2048 nt
    s_waitcnt vmcnt(6)
    buffer_load_dwordx4 a[248:251], v2, s[56:59], s67 offen offset:3072 nt
    s_add_u32 s67, s7, s25
    s_waitcnt vmcnt(6)
    s_cmp_eq_u32 s9, 0
    s_cbranch_scc1 NT_13
    buffer_load_dwordx4 a[252:255], v2, s[56:59], s67 offen offset:0 nt
NT_13:
    s_add_u32 s64, s8, s24
    buffer_load_dwordx4 v[56:59], v1, s[44:47], s64 offen offset:1024 nt
    s_waitcnt vmcnt(6)
    buffer_load_dwordx4 v[60:63], v1, s[44:47], s64 offen offset:2048 nt
    s_waitcnt vmcnt(6)
    buffer_load_dwordx4 v[64:67], v1, s[44:47], s64 offen offset:3072 nt
    s_mov_b32 s28, 2
QA_14:
    s_cmp_ge_u32 s26, s27
    s_cbranch_scc1 QB_15
    buffer_load_dwordx4 v[52:55], v19, s[80:83], s15 offen sc1
    s_waitcnt vmcnt(3)
    buffer_load_dwordx4 v[48:51], v1, s[44:47], s26 offen offset:0
    s_waitcnt vmcnt(3)
    buffer_load_dwordx4 v[48:51], v1, s[44:47], s26 offen offset:1024
    s_add_u32 s26, s26, 2048
    v_max3_u32 v22, v52, v53, v54
    v_max3_u32 v22, v22, v55, v55
    v_cmp_eq_u32_e64 vcc, -1, v22
    s_cbranch_vccnz QA_14
    s_branch L_Q2D
QB_15:
    buffer_load_dwordx4 v[52:55], v19, s[80:83], s15 offen sc1
    s_waitcnt vmcnt(0)
    v_max3_u32 v22, v52, v53, v54
    v_max3_u32 v22, v22, v55, v55
    v_cmp_eq_u32 vcc, -1, v22
    s_cbranch_vccz L_Q2D
    s_cmp_eq_u32 s62, 0
    s_cbranch_scc1 L_Q2D
    s_sub_u32 s62, s62, 1
    s_branch QB_15
L_TB2:
    s_waitcnt vmcnt(19)
    s_add_u32 s67, s7, s18
    buffer_load_dwordx4 a[140:143], v2, s[56:59], s67 offen offset:0 nt
    s_waitcnt vmcnt(19)
    buffer_load_dwordx4 a[144:147], v2, s[56:59], s67 offen offset:1024 nt
    s_waitcnt vmcnt(19)
    buffer_load_dwordx4 a[148:151], v2, s[56:59], s67 offen offset:2048 nt
    s_waitcnt vmcnt(19)
    buffer_load_dwordx4 a[152:155], v2, s[56:59], s67 offen offset:3072 nt
L_TB3:
    s_waitcnt vmcnt(19)
    s_add_u32 s67, s7, s19
    buffer_load_dwordx4 a[156:159], v2, s[56:59], s67 offen offset:0 nt
    s_waitcnt vmcnt(19)
    buffer_load_dwordx4 a[160:163], v2, s[56:59], s67 offen offset:1024 nt
    s_waitcnt vmcnt(19)
    buffer_load_dwordx4 a[164:167], v2, s[56:59], s67 offen offset:2048 nt
    s_waitcnt vmcnt(19)
    buffer_load_dwordx4 a[168:171], v2, s[56:59], s67 offen offset:3072 nt
L_TB4:
    s_waitcnt vmcnt(19)
    s_add_u32 s67, s7, s20
    buffer_load_dwordx4 a[172:175], v2, s[56:59], s67 offen offset:0 nt
    s_waitcnt vmcnt(19)
    buffer_load_dwordx4 a[176:179], v2, s[56:59], s67 offen offset:1024 nt
    s_waitcnt vmcnt(19)
    buffer_load_dwordx4 a[180:183], v2, s[56:59], s67 offen offset:2048 nt
    s_waitcnt vmcnt(19)
    buffer_load_dwordx4 a[184:187], v2, s[56:59], s67 offen offset:3072 nt
L_TB5:
    s_waitcnt vmcnt(19)
    s_add_u32 s67, s7, s21
    buffer_load_dwordx4 a[188:191], v2, s[56:59], s67 offen offset:0 nt
    s_waitcnt vmcnt(19)
    buffer_load_dwordx4 a[192:195], v2, s[56:59], s67 offen offset:1024 nt
    s_waitcnt vmcnt(19)
    buffer_load_dwordx4 a[196:199], v2, s[56:59], s67 offen offset:2048 nt
    s_waitcnt vmcnt(19)
    buffer_load_dwordx4 a[200:203], v2, s[56:59], s67 offen offset:3072 nt
L_TB6:
    s_waitcnt vmcnt(19)
    s_add_u32 s67, s7, s22
    buffer_load_dwordx4 a[204:207], v2, s[56:59], s67 offen offset:0 nt
    s_waitcnt vmcnt(19)
    buffer_load_dwordx4 a[208:211], v2, s[56:59], s67 offen offset:1024 nt
    s_waitcnt vmcnt(19)
    buffer_load_dwordx4 a[212:215], v2, s[56:59], s67 offen offset:2048 nt
    s_waitcnt vmcnt(19)
    buffer_load_dwordx4 a[216:219], v2, s[56:59], s67 offen offset:3072 nt
    s_waitcnt vmcnt(19)
    s_add_u32 s67, s7, s23
    buffer_load_dwordx4 a[220:223], v2, s[56:59], s67 offen offset:0 nt
    s_waitcnt vmcnt(19)
    buffer_load_dwordx4 a[224:227], v2, s[56:59], s67 offen offset:1024 nt
    s_waitcnt vmcnt(19)
    buffer_load_dwordx4 a[228:231], v2, s[56:59], s67 offen offset:2048 nt
    s_waitcnt vmcnt(19)
    buffer_load_dwordx4 a[232:235], v2, s[56:59], s67 offen offset:3072 nt
    s_waitcnt vmcnt(19)
    s_add_u32 s67, s7, s24
    buffer_load_dwordx4 a[236:239], v2, s[56:59], s67 offen offset:0 nt
    s_waitcnt vmcnt(19)
    buffer_load_dwordx4 a[240:243], v2, s[56:59], s67 offen offset:1024 nt
    s_waitcnt vmcnt(19)
    buffer_load_dwordx4 a[244:247], v2, s[56:59], s67 offen offset:2048 nt
    s_waitcnt vmcnt(19)
    buffer_load_dwordx4 a[248:251], v2, s[56:59], s67 offen offset:3072 nt
    s_waitcnt vmcnt(19)
    s_add_u32 s67, s7, s25
    s_cmp_eq_u32 s9, 0
    s_cbranch_scc1 NT_16
    buffer_load_dwordx4 a[252:255], v2, s[56:59], s67 offen offset:0 nt
NT_16:
    s_waitcnt vmcnt(19)
    s_add_u32 s64, s8, s24
    buffer_load_dwordx4 v[56:59], v1, s[44:47], s64 offen offset:1024 nt
    s_waitcnt vmcnt(19)
    buffer_load_dwordx4 v[60:63], v1, s[44:47], s64 offen offset:2048 nt
    s_waitcnt vmcnt(19)
    buffer_load_dwordx4 v[64:67], v1, s[44:47], s64 offen offset:3072 nt
    s_mov_b32 s28, 1
L_Q2D:
    s_nop 0
    v_cndmask_b32 v32, 0, v52, s[70:71]
    v_cndmask_b32 v33, 0, v53, s[70:71]
    v_cndmask_b32 v34, 0, v54, s[70:71]
    v_cndmask_b32 v35, 0, v55, s[70:71]
    v_cndmask_b32 v36, 0, v52, s[72:73]
    v_cndmask_b32 v37, 0, v53, s[72:73]
    v_cndmask_b32 v38, 0, v54, s[72:73]
    v_cndmask_b32 v39, 0, v55, s[72:73]
    v_cndmask_b32 v40, 0, v52, s[74:75]
    v_cndmask_b32 v41, 0, v53, s[74:75]
    v_cndmask_b32 v42, 0, v54, s[74:75]
    v_cndmask_b32 v43, 0, v55, s[74:75]
    v_cndmask_b32 v44, 0, v52, s[76:77]
    v_cndmask_b32 v45, 0, v53, s[76:77]
    v_cndmask_b32 v46, 0, v54, s[76:77]
    v_cndmask_b32 v47, 0, v55, s[76:77]
    s_waitcnt vmcnt(34)
    s_nop 0
    v_mfma_f32_16x16x32_bf16 v[24:27], v[216:219], v[32:35], 0
    v_mfma_f32_16x16x32_bf16 v[24:27], v[220:223], v[36:39], v[24:27]
    v_mfma_f32_16x16x32_bf16 v[24:27], v[224:227], v[40:43], v[24:27]
    v_mfma_f32_16x16x32_bf16 v[24:27], v[228:231], v[44:47], v[24:27]
    v_mfma_f32_16x16x32_bf16 v[20:23], v[232:235], v[32:35], 0
    v_mfma_f32_16x16x32_bf16 v[20:23], v[236:239], v[36:39], v[20:23]
    v_mfma_f32_16x16x32_bf16 v[20:23], v[240:243], v[40:43], v[20:23]
    v_mfma_f32_16x16x32_bf16 v[20:23], v[244:247], v[44:47], v[20:23]
    s_cmp_lg_u32 s28, 0
    s_cbranch_scc1 H2_17
    s_add_u32 s67, s7, s24
    buffer_load_dwordx4 a[244:247], v2, s[56:59], s67 offen offset:2048 nt
H2_17:
    v_mfma_f32_16x16x32_bf16 v[28:31], v[248:251], v[32:35], 0
    s_nop 0
    v_mov_b32_dpp v9, v24 quad_perm:[0,0,0,0] row_mask:0xf bank_mask:0xf
    v_mfma_f32_16x16x32_bf16 v[28:31], v[252:255], v[36:39], v[28:31]
    v_nop_e64
    v_add_f32_dpp v9, v25, v9 quad_perm:[1,1,1,1] row_mask:0xf bank_mask:0xf
    v_mfma_f32_16x16x32_bf16 v[28:31], a[0:3], v[40:43], v[28:31]
    v_nop_e64
    v_add_f32_dpp v9, v26, v9 quad_perm:[2,2,2,2] row_mask:0xf bank_mask:0xf
    v_mfma_f32_16x16x32_bf16 v[28:31], a[4:7], v[44:47], v[28:31]
    v_nop_e64
    v_add_f32_dpp v9, v27, v9 quad_perm:[3,3,3,3] row_mask:0xf bank_mask:0xf
    v_mfma_f32_16x16x32_bf16 v[24:27], a[8:11], v[32:35], 0
    v_mov_b32_dpp v10, v20 quad_perm:[0,0,0,0] row_mask:0xf bank_mask:0xf
    v_mfma_f32_16x16x32_bf16 v[24:27], a[12:15], v[36:39], v[24:27]
    v_nop_e64
    v_add_f32_dpp v10, v21, v10 quad_perm:[1,1,1,1] row_mask:0xf bank_mask:0xf
    v_mfma_f32_16x16x32_bf16 v[24:27], a[16:19], v[40:43], v[24:27]
    v_nop_e64
    v_add_f32_dpp v10, v22, v10 quad_perm:[2,2,2,2] row_mask:0xf bank_mask:0xf
    v_mfma_f32_16x16x32_bf16 v[24:27], a[20:23], v[44:47], v[24:27]
    v_nop_e64
    v_add_f32_dpp v10, v23, v10 quad_perm:[3,3,3,3] row_mask:0xf bank_mask:0xf
    v_mfma_f32_16x16x32_bf16 v[20:23], a[24:27], v[32:35], 0
    v_mov_b32_dpp v11, v28 quad_perm:[0,0,0,0] row_mask:0xf bank_mask:0xf
    v_mfma_f32_16x16x32_bf16 v[20:23], a[28:31], v[36:39], v[20:23]
    v_nop_e64
    v_add_f32_dpp v11, v29, v11 quad_perm:[1,1,1,1] row_mask:0xf bank_mask:0xf
    v_mfma_f32_16x16x32_bf16 v[20:23], a[32:35], v[40:43], v[20:23]
    v_nop_e64
    v_add_f32_dpp v11, v30, v11 quad_perm:[2,2,2,2] row_mask:0xf bank_mask:0xf
    v_mfma_f32_16x16x32_bf16 v[20:23], a[36:39], v[44:47], v[20:23]
    v_nop_e64
    v_add_f32_dpp v11, v31, v11 quad_perm:[3,3,3,3] row_mask:0xf bank_mask:0xf
    s_cmp_lg_u32 s28, 0
    s_cbranch_scc1 H2_18
    buffer_load_dwordx4 a[248:251], v2, s[56:59], s67 offen offset:3072 nt
H2_18:
    v_mfma_f32_16x16x32_bf16 v[28:31], a[40:43], v[32:35], 0
    v_mov_b32_dpp v12, v24 quad_perm:[0,0,0,0] row_mask:0xf bank_mask:0xf
    v_mfma_f32_16x16x32_bf16 v[28:31], a[44:47], v[36:39], v[28:31]
    v_nop_e64
    v_add_f32_dpp v12, v25, v12 quad_perm:[1,1,1,1] row_mask:0xf bank_mask:0xf
    v_mfma_f32_16x16x32_bf16 v[28:31], a[48:51], v[40:43], v[28:31]
    v_nop_e64
    v_add_f32_dpp v12, v26, v12 quad_perm:[2,2,2,2] row_mask:0xf bank_mask:0xf
    v_mfma_f32_16x16x32_bf16 v[28:31], a[52:55], v[44:47], v[28:31]
    v_nop_e64
    v_add_f32_dpp v12, v27, v12 quad_perm:[3,3,3,3] row_mask:0xf bank_mask:0xf
    v_mfma_f32_16x16x32_bf16 v[24:27], a[56:59], v[32:35], 0
    v_mov_b32_dpp v13, v20 quad_perm:[0,0,0,0] row_mask:0xf bank_mask:0xf
    v_mfma_f32_16x16x32_bf16 v[24:27], a[60:63], v[36:39], v[24:27]
    v_nop_e64
    v_add_f32_dpp v13, v21, v13 quad_perm:[1,1,1,1] row_mask:0xf bank_mask:0xf
    v_mfma_f32_16x16x32_bf16 v[24:27], a[64:67], v[40:43], v[24:27]
    v_nop_e64
    v_add_f32_dpp v13, v22, v13 quad_perm:[2,2,2,2] row_mask:0xf bank_mask:0xf
    v_mfma_f32_16x16x32_bf16 v[24:27], a[68:71], v[44:47], v[24:27]
    v_nop_e64
    v_add_f32_dpp v13, v23, v13 quad_perm:[3,3,3,3] row_mask:0xf bank_mask:0xf
    v_mfma_f32_16x16x32_bf16 v[20:23], a[72:75], v[32:35], 0
    v_mov_b32_dpp v14, v28 quad_perm:[0,0,0,0] row_mask:0xf bank_mask:0xf
    v_mfma_f32_16x16x32_bf16 v[20:23], a[76:79], v[36:39], v[20:23]
    v_nop_e64
    v_add_f32_dpp v14, v29, v14 quad_perm:[1,1,1,1] row_mask:0xf bank_mask:0xf
    v_mfma_f32_16x16x32_bf16 v[20:23], a[80:83], v[40:43], v[20:23]
    v_nop_e64
    v_add_f32_dpp v14, v30, v14 quad_perm:[2,2,2,2] row_mask:0xf bank_mask:0xf
    v_mfma_f32_16x16x32_bf16 v[20:23], a[84:87], v[44:47], v[20:23]
    v_nop_e64
    v_add_f32_dpp v14, v31, v14 quad_perm:[3,3,3,3] row_mask:0xf bank_mask:0xf
    s_cmp_lg_u32 s28, 0
    s_cbranch_scc1 H2_19
    s_add_u32 s67, s7, s25
    s_cmp_eq_u32 s9, 0
    s_cbranch_scc1 NT_20
    buffer_load_dwordx4 a[252:255], v2, s[56:59], s67 offen offset:0 nt
NT_20:
H2_19:
    v_mfma_f32_16x16x32_bf16 v[28:31], a[88:91], v[32:35], 0
    v_mov_b32_dpp v15, v24 quad_perm:[0,0,0,0] row_mask:0xf bank_mask:0xf
    v_mfma_f32_16x16x32_bf16 v[28:31], a[92:95], v[36:39], v[28:31]
    s_nop 0
    v_add_f32_dpp v15, v25, v15 quad_perm:[1,1,1,1] row_mask:0xf bank_mask:0xf
    v_mfma_f32_16x16x32_bf16 v[28:31], a[96:99], v[40:43], v[28:31]
    v_nop_e64
    v_add_f32_dpp v15, v26, v15 quad_perm:[2,2,2,2] row_mask:0xf bank_mask:0xf
    v_mfma_f32_16x16x32_bf16 v[28:31], a[100:103], v[44:47], v[28:31]
    v_nop_e64
    v_add_f32_dpp v15, v27, v15 quad_perm:[3,3,3,3] row_mask:0xf bank_mask:0xf
    v_mfma_f32_16x16x32_bf16 v[24:27], a[104:107], v[32:35], 0
    v_mov_b32_dpp v16, v20 quad_perm:[0,0,0,0] row_mask:0xf bank_mask:0xf
    s_nop 0
    s_nop 0
    v_add_f32_dpp v16, v21, v16 quad_perm:[1,1,1,1] row_mask:0xf bank_mask:0xf
    s_nop 0
    s_nop 0
    v_add_f32_dpp v16, v22, v16 quad_perm:[2,2,2,2] row_mask:0xf bank_mask:0xf
    s_nop 0
    s_nop 0
    v_add_f32_dpp v16, v23, v16 quad_perm:[3,3,3,3] row_mask:0xf bank_mask:0xf
    v_mov_b32_dpp v17, v28 quad_perm:[0,0,0,0] row_mask:0xf bank_mask:0xf
    v_add_f32_dpp v18, v24, v8 quad_perm:[0,0,0,0] row_mask:0xf bank_mask:0xf
    v_nop_e64
    v_add_f32_dpp v17, v29, v17 quad_perm:[1,1,1,1] row_mask:0xf bank_mask:0xf
    v_add_f32_dpp v18, v25, v18 quad_perm:[1,1,1,1] row_mask:0xf bank_mask:0xf
    v_nop_e64
    v_add_f32_dpp v17, v30, v17 quad_perm:[2,2,2,2] row_mask:0xf bank_mask:0xf
    v_add_f32_dpp v18, v26, v18 quad_perm:[2,2,2,2] row_mask:0xf bank_mask:0xf
    v_nop_e64
    v_add_f32_dpp v17, v31, v17 quad_perm:[3,3,3,3] row_mask:0xf bank_mask:0xf
    v_add_f32_dpp v18, v27, v18 quad_perm:[3,3,3,3] row_mask:0xf bank_mask:0xf
    v_max3_f32 v20, v9, v10, v11
    v_max3_f32 v21, v12, v13, v14
    v_max3_f32 v20, v20, v15, v16
    v_max3_f32 v21, v21, v17, v18
    v_max_f32 v20, v20, v21
    s_nop 1
    v_max_f32_dpp v20, v20, v20 row_ror:4 row_mask:0xf bank_mask:0xf
    s_nop 0
    s_nop 0
    v_max_f32_dpp v20, v20, v20 row_ror:8 row_mask:0xf bank_mask:0xf
    v_mov_b32 v23, v20
    s_nop 1
    v_permlane16_swap_b32 v20, v23
    v_max_f32 v20, v20, v23
    v_mov_b32 v23, v20
    s_nop 1
    v_permlane32_swap_b32 v20, v23
    v_max_f32 v20, v20, v23
    v_mul_f32_e64 v20, s63, v20
    v_fma_f32 v9, v9, s63, -v20
    v_fma_f32 v10, v10, s63, -v20
    v_fma_f32 v11, v11, s63, -v20
    v_fma_f32 v12, v12, s63, -v20
    v_fma_f32 v13, v13, s63, -v20
    v_fma_f32 v14, v14, s63, -v20
    v_fma_f32 v15, v15, s63, -v20
    v_fma_f32 v16, v16, s63, -v20
    v_fma_f32 v17, v17, s63, -v20
    v_fma_f32 v18, v18, s63, -v20
    v_exp_f32 v9, v9
    v_exp_f32 v10, v10
    v_exp_f32 v11, v11
    v_exp_f32 v12, v12
    v_exp_f32 v13, v13
    v_exp_f32 v14, v14
    v_exp_f32 v15, v15
    v_exp_f32 v16, v16
    v_exp_f32 v17, v17
    v_exp_f32 v18, v18
    v_add_f32 v21, v9, v10
    v_add_f32 v21, v21, v11
    v_add_f32 v21, v21, v12
    v_add_f32 v21, v21, v13
    v_add_f32 v21, v21, v14
    v_add_f32 v21, v21, v15
    v_add_f32 v21, v21, v16
    v_add_f32 v21, v21, v17
    v_add_f32_e64 v21, v21, v18
    v_cvt_pk_bf16_f32 v9, v9, v9
    v_cvt_pk_bf16_f32 v10, v10, v10
    v_cvt_pk_bf16_f32 v11, v11, v11
    v_cvt_pk_bf16_f32 v12, v12, v12
    v_cvt_pk_bf16_f32 v13, v13, v13
    v_cvt_pk_bf16_f32 v14, v14, v14
    v_cvt_pk_bf16_f32 v15, v15, v15
    v_cvt_pk_bf16_f32 v16, v16, v16
    v_cvt_pk_bf16_f32 v17, v17, v17
    v_cvt_pk_bf16_f32 v18, v18, v18
    v_and_b32 v40, v9, v4
    v_and_b32 v41, v9, v5
    v_and_b32_dpp v42, v9, v6 row_ror:4 row_mask:0xf bank_mask:0xf
    v_and_b32_dpp v43, v9, v7 row_ror:4 row_mask:0xf bank_mask:0xf
    v_and_b32_dpp v44, v9, v4 row_ror:12 row_mask:0xf bank_mask:0xf
    v_and_b32_dpp v45, v9, v5 row_ror:12 row_mask:0xf bank_mask:0xf
    s_waitcnt vmcnt(32)
    v_mfma_f32_16x16x32_bf16 v[32:35], v[40:43], a[108:111], 0
    v_and_b32 v46, v9, v6
    v_and_b32_e64 v47, v9, v7
    v_mfma_f32_16x16x32_bf16 v[36:39], v[40:43], a[116:119], 0
    v_and_b32 v40, v10, v4
    v_and_b32 v41, v10, v5
    v_mfma_f32_16x16x32_bf16 v[32:35], v[44:47], a[112:115], v[32:35]
    v_and_b32_dpp v42, v10, v6 row_ror:4 row_mask:0xf bank_mask:0xf
    v_and_b32_dpp v43, v10, v7 row_ror:4 row_mask:0xf bank_mask:0xf
    v_mfma_f32_16x16x32_bf16 v[36:39], v[44:47], a[120:123], v[36:39]
    s_cmp_lg_u32 s28, 0
    s_cbranch_scc1 H2_21
    s_add_u32 s64, s8, s24
    buffer_load_dwordx4 v[56:59], v1, s[44:47], s64 offen offset:1024 nt
H2_21:
    v_and_b32_dpp v44, v10, v4 row_ror:12 row_mask:0xf bank_mask:0xf
    v_and_b32_dpp v45, v10, v5 row_ror:12 row_mask:0xf bank_mask:0xf
    s_waitcnt vmcnt(29)
    v_mfma_f32_16x16x32_bf16 v[32:35], v[40:43], a[124:127], v[32:35]
    v_and_b32 v46, v10, v6
    v_and_b32 v47, v10, v7
    v_mfma_f32_16x16x32_bf16 v[36:39], v[40:43], a[132:135], v[36:39]
    v_and_b32 v40, v11, v4
    v_and_b32 v41, v11, v5
    v_mfma_f32_16x16x32_bf16 v[32:35], v[44:47], a[128:131], v[32:35]
    v_and_b32_dpp v42, v11, v6 row_ror:4 row_mask:0xf bank_mask:0xf
    v_and_b32_dpp v43, v11, v7 row_ror:4 row_mask:0xf bank_mask:0xf
    v_mfma_f32_16x16x32_bf16 v[36:39], v[44:47], a[136:139], v[36:39]
    v_and_b32_dpp v44, v11, v4 row_ror:12 row_mask:0xf bank_mask:0xf
    v_and_b32_dpp v45, v11, v5 row_ror:12 row_mask:0xf bank_mask:0xf
    s_waitcnt vmcnt(25)
    v_mfma_f32_16x16x32_bf16 v[32:35], v[40:43], a[140:143], v[32:35]
    v_and_b32 v46, v11, v6
    v_and_b32_e64 v47, v11, v7
    v_mfma_f32_16x16x32_bf16 v[36:39], v[40:43], a[148:151], v[36:39]
    v_and_b32 v40, v12, v4
    v_and_b32 v41, v12, v5
    v_mfma_f32_16x16x32_bf16 v[32:35], v[44:47], a[144:147], v[32:35]
    v_and_b32_dpp v42, v12, v6 row_ror:4 row_mask:0xf bank_mask:0xf
    v_and_b32_dpp v43, v12, v7 row_ror:4 row_mask:0xf bank_mask:0xf
    v_mfma_f32_16x16x32_bf16 v[36:39], v[44:47], a[152:155], v[36:39]
    v_and_b32_dpp v44, v12, v4 row_ror:12 row_mask:0xf bank_mask:0xf
    v_and_b32_dpp v45, v12, v5 row_ror:12 row_mask:0xf bank_mask:0xf
    s_waitcnt vmcnt(21)
    v_mfma_f32_16x16x32_bf16 v[32:35], v[40:43], a[156:159], v[32:35]
    v_and_b32 v46, v12, v6
    v_and_b32_e64 v47, v12, v7
    v_mfma_f32_16x16x32_bf16 v[36:39], v[40:43], a[164:167], v[36:39]
    v_and_b32 v40, v13, v4
    v_and_b32 v41, v13, v5
    v_mfma_f32_16x16x32_bf16 v[32:35], v[44:47], a[160:163], v[32:35]
    v_and_b32_dpp v42, v13, v6 row_ror:4 row_mask:0xf bank_mask:0xf
    v_and_b32_dpp v43, v13, v7 row_ror:4 row_mask:0xf bank_mask:0xf
    v_mfma_f32_16x16x32_bf16 v[36:39], v[44:47], a[168:171], v[36:39]
    s_cmp_lg_u32 s28, 0
    s_cbranch_scc1 H2_22
    buffer_load_dwordx4 v[60:63], v1, s[44:47], s64 offen offset:2048 nt
H2_22:
    v_and_b32_dpp v44, v13, v4 row_ror:12 row_mask:0xf bank_mask:0xf
    v_and_b32_dpp v45, v13, v5 row_ror:12 row_mask:0xf bank_mask:0xf
    s_waitcnt vmcnt(18)
    v_mfma_f32_16x16x32_bf16 v[32:35], v[40:43], a[172:175], v[32:35]
    v_and_b32 v46, v13, v6
    v_and_b32_e64 v47, v13, v7
    v_mfma_f32_16x16x32_bf16 v[36:39], v[40:43], a[180:183], v[36:39]
    v_and_b32 v40, v14, v4
    v_and_b32 v41, v14, v5
    v_mfma_f32_16x16x32_bf16 v[32:35], v[44:47], a[176:179], v[32:35]
    v_and_b32_dpp v42, v14, v6 row_ror:4 row_mask:0xf bank_mask:0xf
    v_and_b32_dpp v43, v14, v7 row_ror:4 row_mask:0xf bank_mask:0xf
    v_mfma_f32_16x16x32_bf16 v[36:39], v[44:47], a[184:187], v[36:39]
    v_and_b32_dpp v44, v14, v4 row_ror:12 row_mask:0xf bank_mask:0xf
    v_and_b32_dpp v45, v14, v5 row_ror:12 row_mask:0xf bank_mask:0xf
    s_waitcnt vmcnt(14)
    v_mfma_f32_16x16x32_bf16 v[32:35], v[40:43], a[188:191], v[32:35]
    v_and_b32 v46, v14, v6
    v_and_b32_e64 v47, v14, v7
    v_mfma_f32_16x16x32_bf16 v[36:39], v[40:43], a[196:199], v[36:39]
    v_and_b32 v40, v15, v4
    v_and_b32 v41, v15, v5
    v_mfma_f32_16x16x32_bf16 v[32:35], v[44:47], a[192:195], v[32:35]
    v_and_b32_dpp v42, v15, v6 row_ror:4 row_mask:0xf bank_mask:0xf
    v_and_b32_dpp v43, v15, v7 row_ror:4 row_mask:0xf bank_mask:0xf
    v_mfma_f32_16x16x32_bf16 v[36:39], v[44:47], a[200:203], v[36:39]
    v_and_b32_dpp v44, v15, v4 row_ror:12 row_mask:0xf bank_mask:0xf
    v_and_b32_dpp v45, v15, v5 row_ror:12 row_mask:0xf bank_mask:0xf
    s_waitcnt vmcnt(10)
    v_mfma_f32_16x16x32_bf16 v[32:35], v[40:43], a[204:207], v[32:35]
    v_and_b32 v46, v15, v6
    v_and_b32_e64 v47, v15, v7
    v_mfma_f32_16x16x32_bf16 v[36:39], v[40:43], a[212:215], v[36:39]
    v_and_b32 v40, v16, v4
    v_and_b32 v41, v16, v5
    v_mfma_f32_16x16x32_bf16 v[32:35], v[44:47], a[208:211], v[32:35]
    v_and_b32_dpp v42, v16, v6 row_ror:4 row_mask:0xf bank_mask:0xf
    v_and_b32_dpp v43, v16, v7 row_ror:4 row_mask:0xf bank_mask:0xf
    v_mfma_f32_16x16x32_bf16 v[36:39], v[44:47], a[216:219], v[36:39]
    s_cmp_lg_u32 s28, 0
    s_cbranch_scc1 H2_23
    buffer_load_dwordx4 v[64:67], v1, s[44:47], s64 offen offset:3072 nt
H2_23:
    v_and_b32_dpp v44, v16, v4 row_ror:12 row_mask:0xf bank_mask:0xf
    v_and_b32_dpp v45, v16, v5 row_ror:12 row_mask:0xf bank_mask:0xf
    s_waitcnt vmcnt(7)
    v_mfma_f32_16x16x32_bf16 v[32:35], v[40:43], a[220:223], v[32:35]
    v_and_b32 v46, v16, v6
    v_and_b32_e64 v47, v16, v7
    v_mfma_f32_16x16x32_bf16 v[36:39], v[40:43], a[228:231], v[36:39]
    v_and_b32 v40, v17, v4
    v_and_b32 v41, v17, v5
    v_mfma_f32_16x16x32_bf16 v[32:35], v[44:47], a[224:227], v[32:35]
    v_and_b32_dpp v42, v17, v6 row_ror:4 row_mask:0xf bank_mask:0xf
    v_and_b32_dpp v43, v17, v7 row_ror:4 row_mask:0xf bank_mask:0xf
    v_mfma_f32_16x16x32_bf16 v[36:39], v[44:47], a[232:235], v[36:39]
    v_and_b32_dpp v44, v17, v4 row_ror:12 row_mask:0xf bank_mask:0xf
    v_and_b32_dpp v45, v17, v5 row_ror:12 row_mask:0xf bank_mask:0xf
    s_waitcnt vmcnt(3)
    v_mfma_f32_16x16x32_bf16 v[32:35], v[40:43], a[236:239], v[32:35]
    v_and_b32 v46, v17, v6
    v_and_b32_e64 v47, v17, v7
    v_mfma_f32_16x16x32_bf16 v[36:39], v[40:43], a[244:247], v[36:39]
    v_and_b32 v40, v18, v4
    v_and_b32 v41, v18, v5
    v_mfma_f32_16x16x32_bf16 v[32:35], v[44:47], a[240:243], v[32:35]
    v_and_b32_dpp v42, v18, v6 row_ror:4 row_mask:0xf bank_mask:0xf
    v_and_b32_dpp v43, v18, v7 row_ror:4 row_mask:0xf bank_mask:0xf
    v_mfma_f32_16x16x32_bf16 v[36:39], v[44:47], a[248:251], v[36:39]
    v_nop_e64
    v_mfma_f32_16x16x32_bf16 v[32:35], v[40:43], a[252:255], v[32:35]
    v_mov_b32 v24, 0
    v_mov_b32 v25, 1
    v_subrev_u32 v27, s66, v2
    v_lshrrev_b32 v27, 1, v27
    v_and_b32 v29, 24, v27
    v_mov_b32 v28, s13
    v_add_f32_dpp v21, v21, v21 row_ror:4 row_mask:0xf bank_mask:0xf
    s_nop 0
    s_nop 0
    v_add_f32_dpp v21, v21, v21 row_ror:8 row_mask:0xf bank_mask:0xf
    v_mov_b32 v23, v21
    s_nop 1
    v_permlane16_swap_b32 v21, v23
    v_add_f32 v21, v21, v23
    v_mov_b32 v23, v21
    s_nop 1
    v_permlane32_swap_b32 v21, v23
    v_add_f32 v21, v21, v23
    v_permlane32_swap_b32 v32, v34
    v_permlane32_swap_b32 v33, v35
    v_permlane32_swap_b32 v36, v38
    v_permlane32_swap_b32 v37, v39
    v_add_f32 v32, v32, v38
    v_add_f32_e64 v33, v33, v39
    ds_write_b64 v3, v[32:33] offset:2176
    s_mov_b64 exec, 1
    ds_write_b64 v28, v[20:21] offset:4224
    ds_add_rtn_u32 v26, v24, v25 offset:4
    s_mov_b64 exec, -1
    s_nop 0
    ds_read_b64 v[30:31], v29 offset:4224
    ds_read_b64 v[40:41], v27 offset:2176
    ds_read_b64 v[42:43], v27 offset:2688
    ds_read_b64 v[44:45], v27 offset:3200
    ds_read_b64 v[46:47], v27 offset:3712
    s_add_u32 s65, s11, 185344
    s_waitcnt lgkmcnt(4)
    v_readfirstlane_b32 s15, v26
    v_max_f32_dpp v20, v30, v30 quad_perm:[1,0,3,2] row_mask:0xf bank_mask:0xf
    s_and_b32 s15, s15, 3
    s_cmp_lg_u32 s15, 3
    s_cbranch_scc1 NOTLAST_24
    v_max_f32_dpp v20, v20, v20 quad_perm:[2,3,0,1] row_mask:0xf bank_mask:0xf
    v_sub_f32 v22, v30, v20
    v_exp_f32 v22, v22
    s_nop 0
    v_mul_f32 v21, v31, v22
    s_waitcnt lgkmcnt(0)
    v_mul_f32_dpp v32, v22, v40 row_newbcast:0 row_mask:0xf bank_mask:0xf
    v_mul_f32_dpp v33, v22, v41 row_newbcast:0 row_mask:0xf bank_mask:0xf
    v_add_f32_dpp v21, v21, v21 quad_perm:[1,0,3,2] row_mask:0xf bank_mask:0xf
    v_mul_f32_dpp v34, v22, v42 row_newbcast:1 row_mask:0xf bank_mask:0xf
    v_mul_f32_dpp v35, v22, v43 row_newbcast:1 row_mask:0xf bank_mask:0xf
    v_fmac_f32_dpp v32, v22, v44 row_newbcast:2 row_mask:0xf bank_mask:0xf
    v_fmac_f32_dpp v33, v22, v45 row_newbcast:2 row_mask:0xf bank_mask:0xf
    v_add_f32_dpp v21, v21, v21 quad_perm:[2,3,0,1] row_mask:0xf bank_mask:0xf
    v_fmac_f32_dpp v34, v22, v46 row_newbcast:3 row_mask:0xf bank_mask:0xf
    v_fmac_f32_dpp v35, v22, v47 row_newbcast:3 row_mask:0xf bank_mask:0xf
    v_pk_add_f32 v[32:33], v[32:33], v[34:35]
    v_min_u32 v20, -2, v20
    v_min_u32 v21, -2, v21
    v_min_u32 v32, -2, v32
    v_min_u32_e64 v33, -2, v33
    s_add_u32 s15, s65, s14
    s_add_u32 s65, s65, s68
    s_cmp_eq_u32 s79, 0
    s_cbranch_scc0 PLOC_25
    buffer_store_dwordx2 v[32:33], v27, s[80:83], s15 offen sc1
    s_mov_b64 exec, 1
    buffer_store_dwordx2 v[20:21], v27, s[80:83], s65 offen sc1
    s_mov_b64 exec, -1
    s_branch NOTLAST_24
PLOC_25:
    buffer_store_dwordx2 v[32:33], v27, s[80:83], s15 offen
    s_mov_b64 exec, 1
    buffer_store_dwordx2 v[20:21], v27, s[80:83], s65 offen
    s_mov_b64 exec, -1
NOTLAST_24:
    s_waitcnt lgkmcnt(0)
    s_nop 1
    s_cmp_lt_u32 s6, 3
    s_cselect_b32 s54, s60, 0
    s_cmp_lg_u32 s28, 2
    s_cbranch_scc1 L_NW0
    s_waitcnt vmcnt(0)
L_NW0:
    v_mov_b32 v52, -1
    v_mov_b32 v53, -1
    v_mov_b32 v54, -1
    v_mov_b32_e64 v55, -1
    s_add_u32 s15, s10, 370688
QA_26:
    s_cmp_ge_u32 s26, s27
    s_cbranch_scc1 QB_27
    buffer_load_dwordx4 v[52:55], v19, s[80:83], s15 offen sc1
    s_waitcnt vmcnt(3)
    buffer_load_dwordx4 v[48:51], v1, s[44:47], s26 offen offset:0
    s_waitcnt vmcnt(3)
    buffer_load_dwordx4 v[48:51], v1, s[44:47], s26 offen offset:1024
    s_add_u32 s26, s26, 2048
    v_max3_u32 v22, v52, v53, v54
    v_max3_u32 v22, v22, v55, v55
    v_cmp_eq_u32_e64 vcc, -1, v22
    s_cbranch_vccnz QA_26
    s_branch L_Q3D
QB_27:
    buffer_load_dwordx4 v[48:51], v2, s[88:91], s29 offen offset:0 sc1
    buffer_load_dwordx4 v[48:51], v2, s[88:91], s30 offen offset:0 sc1
    buffer_load_dwordx4 v[48:51], v2, s[88:91], s31 offen offset:0 sc1
    buffer_load_dwordx4 v[48:51], v2, s[92:95], s29 offen offset:0 sc1
    buffer_load_dwordx4 v[48:51], v2, s[92:95], s30 offen offset:0 sc1
    buffer_load_dwordx4 v[48:51], v2, s[92:95], s31 offen offset:0 sc1
QC_28:
    buffer_load_dwordx4 v[52:55], v19, s[80:83], s15 offen sc1
    s_waitcnt vmcnt(0)
    v_max3_u32 v22, v52, v53, v54
    v_max3_u32 v22, v22, v55, v55
    v_cmp_eq_u32 vcc, -1, v22
    s_cbranch_vccz L_Q3D
    s_cmp_eq_u32 s62, 0
    s_cbranch_scc1 L_Q3D
    s_sub_u32 s62, s62, 1
    s_branch QC_28
L_Q3D:
    s_nop 0
    v_cndmask_b32 v32, 0, v52, s[70:71]
    v_cndmask_b32 v33, 0, v53, s[70:71]
    v_cndmask_b32 v34, 0, v54, s[70:71]
    v_cndmask_b32 v35, 0, v55, s[70:71]
    v_cndmask_b32 v36, 0, v52, s[72:73]
    v_cndmask_b32 v37, 0, v53, s[72:73]
    v_cndmask_b32 v38, 0, v54, s[72:73]
    v_cndmask_b32 v39, 0, v55, s[72:73]
    v_cndmask_b32 v40, 0, v52, s[74:75]
    v_cndmask_b32 v41, 0, v53, s[74:75]
    v_cndmask_b32 v42, 0, v54, s[74:75]
    v_cndmask_b32 v43, 0, v55, s[74:75]
    v_cndmask_b32 v44, 0, v52, s[76:77]
    v_cndmask_b32 v45, 0, v53, s[76:77]
    v_cndmask_b32 v46, 0, v54, s[76:77]
    v_cndmask_b32 v47, 0, v55, s[76:77]
    v_mfma_f32_16x16x32_bf16 v[24:27], v[68:71], v[32:35], 0
    v_mfma_f32_16x16x32_bf16 v[24:27], v[72:75], v[36:39], v[24:27]
    v_mfma_f32_16x16x32_bf16 v[24:27], v[76:79], v[40:43], v[24:27]
    v_mfma_f32_16x16x32_bf16 v[24:27], v[80:83], v[44:47], v[24:27]
    s_add_u32 s64, s8, s16
    s_nop 0
    buffer_load_dwordx4 v[68:71], v1, s[44:47], s64 offen offset:0 nt
    buffer_load_dwordx4 v[72:75], v1, s[44:47], s64 offen offset:1024 nt
    buffer_load_dwordx4 v[76:79], v1, s[44:47], s64 offen offset:2048 nt
    buffer_load_dwordx4 v[80:83], v1, s[44:47], s64 offen offset:3072 nt
    v_mfma_f32_16x16x32_bf16 v[20:23], v[164:167], v[32:35], 0
    v_mfma_f32_16x16x32_bf16 v[20:23], v[168:171], v[36:39], v[20:23]
    v_mfma_f32_16x16x32_bf16 v[20:23], v[172:175], v[40:43], v[20:23]
    v_mfma_f32_16x16x32_bf16 v[20:23], v[176:179], v[44:47], v[20:23]
    ds_read_b128 v[164:167], v2 offset:0
    ds_read_b128 v[168:171], v2 offset:1024
    ds_read_b128 v[172:175], v2 offset:2048
    ds_read_b128 v[176:179], v2 offset:3072
    v_mfma_f32_16x16x32_bf16 v[28:31], v[212:215], v[32:35], 0
    v_mov_b32_dpp v9, v24 quad_perm:[0,0,0,0] row_mask:0xf bank_mask:0xf
    s_nop 0
    s_nop 0
    v_add_f32_dpp v9, v25, v9 quad_perm:[1,1,1,1] row_mask:0xf bank_mask:0xf
    s_nop 0
    s_nop 0
    v_add_f32_dpp v9, v26, v9 quad_perm:[2,2,2,2] row_mask:0xf bank_mask:0xf
    s_nop 0
    s_nop 0
    v_add_f32_dpp v9, v27, v9 quad_perm:[3,3,3,3] row_mask:0xf bank_mask:0xf
    s_add_u32 s64, s8, s25
    s_cmp_eq_u32 s9, 0
    s_cbranch_scc1 NT_29
    buffer_load_dwordx4 v[212:215], v1, s[44:47], s64 offen offset:0 nt
NT_29:
    v_mfma_f32_16x16x32_bf16 v[24:27], v[180:183], v[32:35], 0
    v_mov_b32_dpp v15, v20 quad_perm:[0,0,0,0] row_mask:0xf bank_mask:0xf
    v_mfma_f32_16x16x32_bf16 v[24:27], v[184:187], v[36:39], v[24:27]
    s_nop 0
    v_add_f32_dpp v15, v21, v15 quad_perm:[1,1,1,1] row_mask:0xf bank_mask:0xf
    v_mfma_f32_16x16x32_bf16 v[24:27], v[188:191], v[40:43], v[24:27]
    v_nop_e64
    v_add_f32_dpp v15, v22, v15 quad_perm:[2,2,2,2] row_mask:0xf bank_mask:0xf
    v_mfma_f32_16x16x32_bf16 v[24:27], v[192:195], v[44:47], v[24:27]
    v_nop_e64
    v_add_f32_dpp v15, v23, v15 quad_perm:[3,3,3,3] row_mask:0xf bank_mask:0xf
    ds_read_b128 v[180:183], v2 offset:4096
    ds_read_b128 v[184:187], v2 offset:5120
    ds_read_b128 v[188:191], v2 offset:6144
    ds_read_b128 v[192:195], v2 offset:7168
    v_mfma_f32_16x16x32_bf16 v[20:23], v[196:199], v[32:35], 0
    v_add_f32_dpp v18, v28, v8 quad_perm:[0,0,0,0] row_mask:0xf bank_mask:0xf
    v_mfma_f32_16x16x32_bf16 v[20:23], v[200:203], v[36:39], v[20:23]
    v_nop_e64
    v_add_f32_dpp v18, v29, v18 quad_perm:[1,1,1,1] row_mask:0xf bank_mask:0xf
    v_mfma_f32_16x16x32_bf16 v[20:23], v[204:207], v[40:43], v[20:23]
    v_nop_e64
    v_add_f32_dpp v18, v30, v18 quad_perm:[2,2,2,2] row_mask:0xf bank_mask:0xf
    v_mfma_f32_16x16x32_bf16 v[20:23], v[208:211], v[44:47], v[20:23]
    v_nop_e64
    v_add_f32_dpp v18, v31, v18 quad_perm:[3,3,3,3] row_mask:0xf bank_mask:0xf
    ds_read_b128 v[196:199], v2 offset:8192
    ds_read_b128 v[200:203], v2 offset:9216
    ds_read_b128 v[204:207], v2 offset:10240
    ds_read_b128 v[208:211], v2 offset:11264
    s_waitcnt lgkmcnt(8)
    s_add_u32 s67, s8, s16
    s_add_u32 m0, s66, 0
    s_nop 0
    buffer_load_dwordx4 v2, s[48:51], s67 offen offset:0 nt lds
    buffer_load_dwordx4 v2, s[48:51], s67 offen offset:1024 nt lds
    v_mfma_f32_16x16x32_bf16 v[28:31], v[84:87], v[32:35], 0
    v_mov_b32_dpp v16, v24 quad_perm:[0,0,0,0] row_mask:0xf bank_mask:0xf
    v_mfma_f32_16x16x32_bf16 v[28:31], v[88:91], v[36:39], v[28:31]
    v_nop_e64
    v_add_f32_dpp v16, v25, v16 quad_perm:[1,1,1,1] row_mask:0xf bank_mask:0xf
    v_mfma_f32_16x16x32_bf16 v[28:31], v[92:95], v[40:43], v[28:31]
    v_nop_e64
    v_add_f32_dpp v16, v26, v16 quad_perm:[2,2,2,2] row_mask:0xf bank_mask:0xf
    v_mfma_f32_16x16x32_bf16 v[28:31], v[96:99], v[44:47], v[28:31]
    v_nop_e64
    v_add_f32_dpp v16, v27, v16 quad_perm:[3,3,3,3] row_mask:0xf bank_mask:0xf
    s_waitcnt lgkmcnt(4)
    v_mfma_f32_16x16x32_bf16 v[24:27], v[100:103], v[32:35], 0
    v_mov_b32_dpp v17, v20 quad_perm:[0,0,0,0] row_mask:0xf bank_mask:0xf
    v_mfma_f32_16x16x32_bf16 v[24:27], v[104:107], v[36:39], v[24:27]
    s_nop 0
    v_add_f32_dpp v17, v21, v17 quad_perm:[1,1,1,1] row_mask:0xf bank_mask:0xf
    v_mfma_f32_16x16x32_bf16 v[24:27], v[108:111], v[40:43], v[24:27]
    v_nop_e64
    v_add_f32_dpp v17, v22, v17 quad_perm:[2,2,2,2] row_mask:0xf bank_mask:0xf
    v_mfma_f32_16x16x32_bf16 v[24:27], v[112:115], v[44:47], v[24:27]
    v_nop_e64
    v_add_f32_dpp v17, v23, v17 quad_perm:[3,3,3,3] row_mask:0xf bank_mask:0xf
    s_waitcnt lgkmcnt(0)
    v_mfma_f32_16x16x32_bf16 v[20:23], v[116:119], v[32:35], 0
    v_mov_b32_dpp v10, v28 quad_perm:[0,0,0,0] row_mask:0xf bank_mask:0xf
    v_mfma_f32_16x16x32_bf16 v[20:23], v[120:123], v[36:39], v[20:23]
    s_nop 0
    v_add_f32_dpp v10, v29, v10 quad_perm:[1,1,1,1] row_mask:0xf bank_mask:0xf
    v_mfma_f32_16x16x32_bf16 v[20:23], v[124:127], v[40:43], v[20:23]
    v_nop_e64
    v_add_f32_dpp v10, v30, v10 quad_perm:[2,2,2,2] row_mask:0xf bank_mask:0xf
    v_mfma_f32_16x16x32_bf16 v[20:23], v[128:131], v[44:47], v[20:23]
    v_nop_e64
    v_add_f32_dpp v10, v31, v10 quad_perm:[3,3,3,3] row_mask:0xf bank_mask:0xf
    s_add_u32 s64, s8, s17
    buffer_load_dwordx4 v[84:87], v1, s[44:47], s64 offen offset:0 nt
    v_mfma_f32_16x16x32_bf16 v[28:31], v[132:135], v[32:35], 0
    v_mov_b32_dpp v11, v24 quad_perm:[0,0,0,0] row_mask:0xf bank_mask:0xf
    v_mfma_f32_16x16x32_bf16 v[28:31], v[136:139], v[36:39], v[28:31]
    s_nop 0
    v_add_f32_dpp v11, v25, v11 quad_perm:[1,1,1,1] row_mask:0xf bank_mask:0xf
    v_mfma_f32_16x16x32_bf16 v[28:31], v[140:143], v[40:43], v[28:31]
    v_nop_e64
    v_add_f32_dpp v11, v26, v11 quad_perm:[2,2,2,2] row_mask:0xf bank_mask:0xf
    v_mfma_f32_16x16x32_bf16 v[28:31], v[144:147], v[44:47], v[28:31]
    v_nop_e64
    v_add_f32_dpp v11, v27, v11 quad_perm:[3,3,3,3] row_mask:0xf bank_mask:0xf
    v_mfma_f32_16x16x32_bf16 v[24:27], v[148:151], v[32:35], 0
    v_mov_b32_dpp v12, v20 quad_perm:[0,0,0,0] row_mask:0xf bank_mask:0xf
    v_mfma_f32_16x16x32_bf16 v[24:27], v[152:155], v[36:39], v[24:27]
    v_nop_e64
    v_add_f32_dpp v12, v21, v12 quad_perm:[1,1,1,1] row_mask:0xf bank_mask:0xf
    v_mfma_f32_16x16x32_bf16 v[24:27], v[156:159], v[40:43], v[24:27]
    v_nop_e64
    v_add_f32_dpp v12, v22, v12 quad_perm:[2,2,2,2] row_mask:0xf bank_mask:0xf
    v_mfma_f32_16x16x32_bf16 v[24:27], v[160:163], v[44:47], v[24:27]
    v_nop_e64
    v_add_f32_dpp v12, v23, v12 quad_perm:[3,3,3,3] row_mask:0xf bank_mask:0xf
    buffer_load_dwordx4 v[88:91], v1, s[44:47], s64 offen offset:1024 nt
    v_mov_b32_dpp v13, v28 quad_perm:[0,0,0,0] row_mask:0xf bank_mask:0xf
    s_nop 2
    s_nop 0
    v_mov_b32_dpp v14, v24 quad_perm:[0,0,0,0] row_mask:0xf bank_mask:0xf
    v_add_f32_dpp v13, v29, v13 quad_perm:[1,1,1,1] row_mask:0xf bank_mask:0xf
    v_nop_e64
    v_add_f32_dpp v14, v25, v14 quad_perm:[1,1,1,1] row_mask:0xf bank_mask:0xf
    v_add_f32_dpp v13, v30, v13 quad_perm:[2,2,2,2] row_mask:0xf bank_mask:0xf
    v_nop_e64
    v_add_f32_dpp v14, v26, v14 quad_perm:[2,2,2,2] row_mask:0xf bank_mask:0xf
    v_add_f32_dpp v13, v31, v13 quad_perm:[3,3,3,3] row_mask:0xf bank_mask:0xf
    v_nop_e64
    v_add_f32_dpp v14, v27, v14 quad_perm:[3,3,3,3] row_mask:0xf bank_mask:0xf
    v_max3_f32 v20, v9, v10, v11
    v_max3_f32 v21, v12, v13, v14
    v_max3_f32 v20, v20, v15, v16
    v_max3_f32 v21, v21, v17, v18
    v_max_f32 v20, v20, v21
    s_nop 1
    v_max_f32_dpp v20, v20, v20 row_ror:4 row_mask:0xf bank_mask:0xf
    s_nop 0
    s_nop 0
    v_max_f32_dpp v20, v20, v20 row_ror:8 row_mask:0xf bank_mask:0xf
    v_mov_b32 v23, v20
    s_nop 1
    v_permlane16_swap_b32 v20, v23
    v_max_f32 v20, v20, v23
    v_mov_b32 v23, v20
    s_nop 1
    v_permlane32_swap_b32 v20, v23
    v_max_f32 v20, v20, v23
    v_mul_f32_e64 v20, s63, v20
    v_fma_f32 v9, v9, s63, -v20
    v_fma_f32 v10, v10, s63, -v20
    v_fma_f32 v11, v11, s63, -v20
    v_fma_f32 v12, v12, s63, -v20
    v_fma_f32 v13, v13, s63, -v20
    v_fma_f32 v14, v14, s63, -v20
    v_fma_f32 v15, v15, s63, -v20
    v_fma_f32 v16, v16, s63, -v20
    v_fma_f32 v17, v17, s63, -v20
    v_fma_f32 v18, v18, s63, -v20
    v_exp_f32 v9, v9
    v_exp_f32 v10, v10
    v_exp_f32 v11, v11
    v_exp_f32 v12, v12
    v_exp_f32 v13, v13
    v_exp_f32 v14, v14
    v_exp_f32 v15, v15
    v_exp_f32 v16, v16
    v_exp_f32 v17, v17
    v_exp_f32 v18, v18
    v_add_f32 v21, v9, v10
    v_add_f32 v21, v21, v11
    v_add_f32 v21, v21, v12
    v_add_f32 v21, v21, v13
    v_add_f32 v21, v21, v14
    v_add_f32 v21, v21, v15
    v_add_f32 v21, v21, v16
    v_add_f32 v21, v21, v17
    v_add_f32_e64 v21, v21, v18
    v_cvt_pk_bf16_f32 v9, v9, v9
    v_cvt_pk_bf16_f32 v10, v10, v10
    v_cvt_pk_bf16_f32 v11, v11, v11
    v_cvt_pk_bf16_f32 v12, v12, v12
    v_cvt_pk_bf16_f32 v13, v13, v13
    v_cvt_pk_bf16_f32 v14, v14, v14
    v_cvt_pk_bf16_f32 v15, v15, v15
    v_cvt_pk_bf16_f32 v16, v16, v16
    v_cvt_pk_bf16_f32 v17, v17, v17
    v_cvt_pk_bf16_f32 v18, v18, v18
    v_and_b32 v40, v9, v4
    v_and_b32 v41, v9, v5
    v_and_b32_dpp v42, v9, v6 row_ror:4 row_mask:0xf bank_mask:0xf
    v_and_b32_dpp v43, v9, v7 row_ror:4 row_mask:0xf bank_mask:0xf
    v_and_b32_dpp v44, v9, v4 row_ror:12 row_mask:0xf bank_mask:0xf
    v_and_b32_dpp v45, v9, v5 row_ror:12 row_mask:0xf bank_mask:0xf
    v_mfma_f32_16x16x32_bf16 v[32:35], v[40:43], v[164:167], 0
    v_and_b32 v46, v9, v6
    v_and_b32 v47, v9, v7
    v_mfma_f32_16x16x32_bf16 v[36:39], v[40:43], v[172:175], 0
    v_and_b32 v40, v10, v4
    v_and_b32 v41, v10, v5
    v_mfma_f32_16x16x32_bf16 v[32:35], v[44:47], v[168:171], v[32:35]
    v_and_b32_dpp v42, v10, v6 row_ror:4 row_mask:0xf bank_mask:0xf
    v_and_b32_dpp v43, v10, v7 row_ror:4 row_mask:0xf bank_mask:0xf
    v_mfma_f32_16x16x32_bf16 v[36:39], v[44:47], v[176:179], v[36:39]
    ds_read_b128 v[164:167], v2 offset:12288
    ds_read_b128 v[168:171], v2 offset:13312
    ds_read_b128 v[172:175], v2 offset:14336
    ds_read_b128 v[176:179], v2 offset:15360
    buffer_load_dwordx4 v[92:95], v1, s[44:47], s64 offen offset:2048 nt
    v_and_b32_dpp v44, v10, v4 row_ror:12 row_mask:0xf bank_mask:0xf
    v_and_b32_dpp v45, v10, v5 row_ror:12 row_mask:0xf bank_mask:0xf
    v_mfma_f32_16x16x32_bf16 v[32:35], v[40:43], v[180:183], v[32:35]
    v_and_b32 v46, v10, v6
    v_and_b32 v47, v10, v7
    v_mfma_f32_16x16x32_bf16 v[36:39], v[40:43], v[188:191], v[36:39]
    v_and_b32 v40, v11, v4
    v_and_b32 v41, v11, v5
    v_mfma_f32_16x16x32_bf16 v[32:35], v[44:47], v[184:187], v[32:35]
    v_and_b32_dpp v42, v11, v6 row_ror:4 row_mask:0xf bank_mask:0xf
    v_and_b32_dpp v43, v11, v7 row_ror:4 row_mask:0xf bank_mask:0xf
    v_mfma_f32_16x16x32_bf16 v[36:39], v[44:47], v[192:195], v[36:39]
    ds_read_b128 v[180:183], v2 offset:16384
    ds_read_b128 v[184:187], v2 offset:17408
    ds_read_b128 v[188:191], v2 offset:18432
    ds_read_b128 v[192:195], v2 offset:19456
    v_and_b32_dpp v44, v11, v4 row_ror:12 row_mask:0xf bank_mask:0xf
    v_and_b32_dpp v45, v11, v5 row_ror:12 row_mask:0xf bank_mask:0xf
    v_mfma_f32_16x16x32_bf16 v[32:35], v[40:43], v[196:199], v[32:35]
    v_and_b32 v46, v11, v6
    v_and_b32 v47, v11, v7
    v_mfma_f32_16x16x32_bf16 v[36:39], v[40:43], v[204:207], v[36:39]
    v_and_b32 v40, v12, v4
    v_and_b32 v41, v12, v5
    v_mfma_f32_16x16x32_bf16 v[32:35], v[44:47], v[200:203], v[32:35]
    v_and_b32_dpp v42, v12, v6 row_ror:4 row_mask:0xf bank_mask:0xf
    v_and_b32_dpp v43, v12, v7 row_ror:4 row_mask:0xf bank_mask:0xf
    v_mfma_f32_16x16x32_bf16 v[36:39], v[44:47], v[208:211], v[36:39]
    ds_read_b128 v[196:199], v2 offset:20480
    ds_read_b128 v[200:203], v2 offset:21504
    ds_read_b128 v[204:207], v2 offset:22528
    ds_read_b128 v[208:211], v2 offset:23552
    v_and_b32_dpp v44, v12, v4 row_ror:12 row_mask:0xf bank_mask:0xf
    v_and_b32_dpp v45, v12, v5 row_ror:12 row_mask:0xf bank_mask:0xf
    s_waitcnt lgkmcnt(8)
    v_mfma_f32_16x16x32_bf16 v[32:35], v[40:43], v[164:167], v[32:35]
    v_and_b32 v46, v12, v6
    v_and_b32_e64 v47, v12, v7
    v_mfma_f32_16x16x32_bf16 v[36:39], v[40:43], v[172:175], v[36:39]
    v_and_b32 v40, v13, v4
    v_and_b32 v41, v13, v5
    v_mfma_f32_16x16x32_bf16 v[32:35], v[44:47], v[168:171], v[32:35]
    v_and_b32_dpp v42, v13, v6 row_ror:4 row_mask:0xf bank_mask:0xf
    v_and_b32_dpp v43, v13, v7 row_ror:4 row_mask:0xf bank_mask:0xf
    v_mfma_f32_16x16x32_bf16 v[36:39], v[44:47], v[176:179], v[36:39]
    ds_read_b128 v[164:167], v2 offset:24576
    ds_read_b128 v[168:171], v2 offset:25600
    ds_read_b128 v[172:175], v2 offset:26624
    ds_read_b128 v[176:179], v2 offset:27648
    buffer_load_dwordx4 v[96:99], v1, s[44:47], s64 offen offset:3072 nt
    v_and_b32_dpp v44, v13, v4 row_ror:12 row_mask:0xf bank_mask:0xf
    v_and_b32_dpp v45, v13, v5 row_ror:12 row_mask:0xf bank_mask:0xf
    s_waitcnt lgkmcnt(8)
    v_mfma_f32_16x16x32_bf16 v[32:35], v[40:43], v[180:183], v[32:35]
    v_and_b32 v46, v13, v6
    v_and_b32_e64 v47, v13, v7
    v_mfma_f32_16x16x32_bf16 v[36:39], v[40:43], v[188:191], v[36:39]
    v_and_b32 v40, v14, v4
    v_and_b32 v41, v14, v5
    v_mfma_f32_16x16x32_bf16 v[32:35], v[44:47], v[184:187], v[32:35]
    v_and_b32_dpp v42, v14, v6 row_ror:4 row_mask:0xf bank_mask:0xf
    v_and_b32_dpp v43, v14, v7 row_ror:4 row_mask:0xf bank_mask:0xf
    v_mfma_f32_16x16x32_bf16 v[36:39], v[44:47], v[192:195], v[36:39]
    ds_read_b128 v[180:183], v2 offset:28672
    ds_read_b128 v[184:187], v2 offset:29696
    ds_read_b128 v[188:191], v2 offset:30720
    ds_read_b128 v[192:195], v2 offset:31744
    v_and_b32_dpp v44, v14, v4 row_ror:12 row_mask:0xf bank_mask:0xf
    v_and_b32_dpp v45, v14, v5 row_ror:12 row_mask:0xf bank_mask:0xf
    s_waitcnt lgkmcnt(8)
    v_mfma_f32_16x16x32_bf16 v[32:35], v[40:43], v[196:199], v[32:35]
    v_and_b32 v46, v14, v6
    v_and_b32_e64 v47, v14, v7
    v_mfma_f32_16x16x32_bf16 v[36:39], v[40:43], v[204:207], v[36:39]
    v_and_b32 v40, v15, v4
    v_and_b32 v41, v15, v5
    v_mfma_f32_16x16x32_bf16 v[32:35], v[44:47], v[200:203], v[32:35]
    v_and_b32_dpp v42, v15, v6 row_ror:4 row_mask:0xf bank_mask:0xf
    v_and_b32_dpp v43, v15, v7 row_ror:4 row_mask:0xf bank_mask:0xf
    v_mfma_f32_16x16x32_bf16 v[36:39], v[44:47], v[208:211], v[36:39]
    ds_read_b128 v[196:199], v2 offset:32768
    ds_read_b128 v[200:203], v2 offset:33792
    ds_read_b128 v[204:207], v2 offset:34816
    ds_read_b128 v[208:211], v2 offset:35840
    v_and_b32_dpp v44, v15, v4 row_ror:12 row_mask:0xf bank_mask:0xf
    v_and_b32_dpp v45, v15, v5 row_ror:12 row_mask:0xf bank_mask:0xf
    s_waitcnt lgkmcnt(8)
    v_mfma_f32_16x16x32_bf16 v[32:35], v[40:43], v[164:167], v[32:35]
    v_and_b32 v46, v15, v6
    v_and_b32_e64 v47, v15, v7
    v_mfma_f32_16x16x32_bf16 v[36:39], v[40:43], v[172:175], v[36:39]
    v_and_b32 v40, v16, v4
    v_and_b32 v41, v16, v5
    v_mfma_f32_16x16x32_bf16 v[32:35], v[44:47], v[168:171], v[32:35]
    v_and_b32_dpp v42, v16, v6 row_ror:4 row_mask:0xf bank_mask:0xf
    v_and_b32_dpp v43, v16, v7 row_ror:4 row_mask:0xf bank_mask:0xf
    v_mfma_f32_16x16x32_bf16 v[36:39], v[44:47], v[176:179], v[36:39]
    ds_read_b128 v[164:167], v2 offset:36864
    s_add_u32 s64, s8, s18
    buffer_load_dwordx4 v[100:103], v1, s[44:47], s64 offen offset:0 nt
    v_and_b32_dpp v44, v16, v4 row_ror:12 row_mask:0xf bank_mask:0xf
    v_and_b32_dpp v45, v16, v5 row_ror:12 row_mask:0xf bank_mask:0xf
    s_waitcnt lgkmcnt(5)
    v_mfma_f32_16x16x32_bf16 v[32:35], v[40:43], v[180:183], v[32:35]
    v_and_b32 v46, v16, v6
    v_and_b32 v47, v16, v7
    v_mfma_f32_16x16x32_bf16 v[36:39], v[40:43], v[188:191], v[36:39]
    v_and_b32 v40, v17, v4
    v_and_b32 v41, v17, v5
    v_mfma_f32_16x16x32_bf16 v[32:35], v[44:47], v[184:187], v[32:35]
    v_and_b32_dpp v42, v17, v6 row_ror:4 row_mask:0xf bank_mask:0xf
    v_and_b32_dpp v43, v17, v7 row_ror:4 row_mask:0xf bank_mask:0xf
    v_mfma_f32_16x16x32_bf16 v[36:39], v[44:47], v[192:195], v[36:39]
    v_and_b32_dpp v44, v17, v4 row_ror:12 row_mask:0xf bank_mask:0xf
    v_and_b32_dpp v45, v17, v5 row_ror:12 row_mask:0xf bank_mask:0xf
    s_waitcnt lgkmcnt(1)
    v_mfma_f32_16x16x32_bf16 v[32:35], v[40:43], v[196:199], v[32:35]
    v_and_b32 v46, v17, v6
    v_and_b32_e64 v47, v17, v7
    v_mfma_f32_16x16x32_bf16 v[36:39], v[40:43], v[204:207], v[36:39]
    v_and_b32 v40, v18, v4
    v_and_b32 v41, v18, v5
    v_mfma_f32_16x16x32_bf16 v[32:35], v[44:47], v[200:203], v[32:35]
    v_and_b32_dpp v42, v18, v6 row_ror:4 row_mask:0xf bank_mask:0xf
    v_and_b32_dpp v43, v18, v7 row_ror:4 row_mask:0xf bank_mask:0xf
    v_mfma_f32_16x16x32_bf16 v[36:39], v[44:47], v[208:211], v[36:39]
    s_waitcnt lgkmcnt(0)
    v_mfma_f32_16x16x32_bf16 v[32:35], v[40:43], v[164:167], v[32:35]
    buffer_load_dwordx4 v[104:107], v1, s[44:47], s64 offen offset:1024 nt
    v_mov_b32 v24, 0
    v_mov_b32 v25, 1
    v_subrev_u32 v27, s66, v2
    v_lshrrev_b32 v27, 1, v27
    v_and_b32 v29, 24, v27
    v_mov_b32_e64 v28, s13
    v_add_f32_dpp v21, v21, v21 row_ror:4 row_mask:0xf bank_mask:0xf
    s_nop 0
    s_nop 0
    v_add_f32_dpp v21, v21, v21 row_ror:8 row_mask:0xf bank_mask:0xf
    v_mov_b32 v23, v21
    s_nop 1
    v_permlane16_swap_b32 v21, v23
    v_add_f32 v21, v21, v23
    v_mov_b32 v23, v21
    s_nop 1
    v_permlane32_swap_b32 v21, v23
    v_add_f32 v21, v21, v23
    v_permlane32_swap_b32 v32, v34
    v_permlane32_swap_b32 v33, v35
    v_permlane32_swap_b32 v36, v38
    v_permlane32_swap_b32 v37, v39
    v_add_f32 v32, v32, v38
    v_add_f32_e64 v33, v33, v39
    ds_write_b64 v3, v[32:33] offset:64
    s_mov_b64 exec, 1
    ds_write_b64 v28, v[20:21] offset:2112
    ds_add_rtn_u32 v26, v24, v25 offset:0
    s_mov_b64 exec, -1
    s_nop 0
    ds_read_b64 v[30:31], v29 offset:2112
    ds_read_b64 v[40:41], v27 offset:64
    ds_read_b64 v[42:43], v27 offset:576
    ds_read_b64 v[44:45], v27 offset:1088
    ds_read_b64 v[46:47], v27 offset:1600
    s_add_u32 s65, s11, 370688
    s_waitcnt lgkmcnt(4)
    v_readfirstlane_b32 s15, v26
    v_max_f32_dpp v20, v30, v30 quad_perm:[1,0,3,2] row_mask:0xf bank_mask:0xf
    s_and_b32 s15, s15, 3
    s_cmp_lg_u32 s15, 3
    s_cbranch_scc1 NOTLAST_30
    v_max_f32_dpp v20, v20, v20 quad_perm:[2,3,0,1] row_mask:0xf bank_mask:0xf
    v_sub_f32 v22, v30, v20
    v_exp_f32 v22, v22
    s_nop 0
    v_mul_f32 v21, v31, v22
    s_waitcnt lgkmcnt(0)
    v_mul_f32_dpp v32, v22, v40 row_newbcast:0 row_mask:0xf bank_mask:0xf
    v_mul_f32_dpp v33, v22, v41 row_newbcast:0 row_mask:0xf bank_mask:0xf
    v_add_f32_dpp v21, v21, v21 quad_perm:[1,0,3,2] row_mask:0xf bank_mask:0xf
    v_mul_f32_dpp v34, v22, v42 row_newbcast:1 row_mask:0xf bank_mask:0xf
    v_mul_f32_dpp v35, v22, v43 row_newbcast:1 row_mask:0xf bank_mask:0xf
    v_fmac_f32_dpp v32, v22, v44 row_newbcast:2 row_mask:0xf bank_mask:0xf
    v_fmac_f32_dpp v33, v22, v45 row_newbcast:2 row_mask:0xf bank_mask:0xf
    v_add_f32_dpp v21, v21, v21 quad_perm:[2,3,0,1] row_mask:0xf bank_mask:0xf
    v_fmac_f32_dpp v34, v22, v46 row_newbcast:3 row_mask:0xf bank_mask:0xf
    v_fmac_f32_dpp v35, v22, v47 row_newbcast:3 row_mask:0xf bank_mask:0xf
    v_pk_add_f32 v[32:33], v[32:33], v[34:35]
    v_min_u32 v20, -2, v20
    v_min_u32 v21, -2, v21
    v_min_u32 v32, -2, v32
    v_min_u32_e64 v33, -2, v33
    s_add_u32 s15, s65, s14
    s_add_u32 s65, s65, s68
    s_cmp_eq_u32 s79, 0
    s_cbranch_scc0 PLOC_31
    buffer_store_dwordx2 v[32:33], v27, s[80:83], s15 offen sc1
    s_mov_b64 exec, 1
    buffer_store_dwordx2 v[20:21], v27, s[80:83], s65 offen sc1
    s_mov_b64 exec, -1
    s_branch NOTLAST_30
PLOC_31:
    buffer_store_dwordx2 v[32:33], v27, s[80:83], s15 offen
    s_mov_b64 exec, 1
    buffer_store_dwordx2 v[20:21], v27, s[80:83], s65 offen
    s_mov_b64 exec, -1
NOTLAST_30:
    s_waitcnt lgkmcnt(0)
    s_nop 1
    s_barrier
    s_waitcnt vmcnt(12)
    v_mov_b64 v[200:201], v[56:57]
    v_mov_b64 v[202:203], v[58:59]
    v_mov_b64 v[204:205], v[60:61]
    v_mov_b64 v[206:207], v[62:63]
    v_mov_b64_e64 v[208:209], v[64:65]
    v_mov_b64 v[210:211], v[66:67]
    s_waitcnt vmcnt(6)
    buffer_load_dwordx4 v[108:111], v1, s[44:47], s64 offen offset:2048 nt
    s_add_u32 s64, s8, s19
    buffer_load_dwordx4 v[120:123], v1, s[44:47], s64 offen offset:1024 nt
    buffer_load_dwordx4 v[124:127], v1, s[44:47], s64 offen offset:2048 nt
    buffer_load_dwordx4 v[128:131], v1, s[44:47], s64 offen offset:3072 nt
    s_add_u32 s64, s8, s20
    buffer_load_dwordx4 v[132:135], v1, s[44:47], s64 offen offset:0 nt
    buffer_load_dwordx4 v[136:139], v1, s[44:47], s64 offen offset:1024 nt
    buffer_load_dwordx4 v[140:143], v1, s[44:47], s64 offen offset:2048 nt
    buffer_load_dwordx4 v[144:147], v1, s[44:47], s64 offen offset:3072 nt
    s_add_u32 s64, s8, s21
    buffer_load_dwordx4 v[148:151], v1, s[44:47], s64 offen offset:0 nt
    s_add_u32 s64, s8, s18
    s_waitcnt vmcnt(14)
    buffer_load_dwordx4 v[112:115], v1, s[44:47], s64 offen offset:3072 nt
    s_add_u32 s64, s8, s21
    buffer_load_dwordx4 v[152:155], v1, s[44:47], s64 offen offset:1024 nt
    buffer_load_dwordx4 v[156:159], v1, s[44:47], s64 offen offset:2048 nt
    buffer_load_dwordx4 v[160:163], v1, s[44:47], s64 offen offset:3072 nt
    s_add_u32 s64, s8, s22
    buffer_load_dwordx4 v[164:167], v1, s[44:47], s64 offen offset:0 nt
    buffer_load_dwordx4 v[168:171], v1, s[44:47], s64 offen offset:1024 nt
    buffer_load_dwordx4 v[172:175], v1, s[44:47], s64 offen offset:2048 nt
    buffer_load_dwordx4 v[176:179], v1, s[44:47], s64 offen offset:3072 nt
    s_add_u32 s64, s8, s23
    buffer_load_dwordx4 v[180:183], v1, s[44:47], s64 offen offset:0 nt
    s_add_u32 s64, s8, s19
    s_waitcnt vmcnt(22)
    buffer_load_dwordx4 v[116:119], v1, s[44:47], s64 offen offset:0 nt
    s_add_u32 s64, s8, s23
    buffer_load_dwordx4 v[184:187], v1, s[44:47], s64 offen offset:1024 nt
    buffer_load_dwordx4 v[188:191], v1, s[44:47], s64 offen offset:2048 nt
    buffer_load_dwordx4 v[192:195], v1, s[44:47], s64 offen offset:3072 nt
    s_add_u32 s64, s8, s24
    buffer_load_dwordx4 v[196:199], v1, s[44:47], s64 offen offset:0 nt
    s_waitcnt vmcnt(26)
    buffer_load_dwordx4 v2, s[48:51], s67 offen offset:2048 nt lds
    s_waitcnt vmcnt(26)
    buffer_load_dwordx4 v2, s[48:51], s67 offen offset:3072 nt lds
    s_add_u32 s67, s8, s17
    s_add_u32 m0, s66, 4096
    s_waitcnt vmcnt(26)
    buffer_load_dwordx4 v2, s[48:51], s67 offen offset:0 nt lds
    s_waitcnt vmcnt(26)
    buffer_load_dwordx4 v2, s[48:51], s67 offen offset:1024 nt lds
    s_waitcnt vmcnt(26)
    buffer_load_dwordx4 v2, s[48:51], s67 offen offset:2048 nt lds
    s_waitcnt vmcnt(18)
    buffer_load_dwordx4 v2, s[48:51], s67 offen offset:3072 nt lds
    s_add_u32 s67, s8, s18
    s_add_u32 m0, s66, 8192
    s_waitcnt vmcnt(10)
    buffer_load_dwordx4 v2, s[48:51], s67 offen offset:0 nt lds
    s_waitcnt vmcnt(6)
    buffer_load_dwordx4 v2, s[48:51], s67 offen offset:1024 nt lds
    s_waitcnt vmcnt(6)
    buffer_load_dwordx4 v2, s[48:51], s67 offen offset:2048 nt lds
    s_waitcnt vmcnt(6)
    buffer_load_dwordx4 v2, s[48:51], s67 offen offset:3072 nt lds
    s_add_u32 s67, s8, s19
    s_add_u32 m0, s66, 12288
    s_waitcnt vmcnt(6)
    buffer_load_dwordx4 v2, s[48:51], s67 offen offset:0 nt lds
    s_waitcnt vmcnt(6)
    buffer_load_dwordx4 v2, s[48:51], s67 offen offset:1024 nt lds
    s_waitcnt vmcnt(6)
    buffer_load_dwordx4 v2, s[48:51], s67 offen offset:2048 nt lds
    s_waitcnt vmcnt(6)
    buffer_load_dwordx4 v2, s[48:51], s67 offen offset:3072 nt lds
    s_add_u32 s67, s8, s20
    s_add_u32 m0, s66, 16384
    s_waitcnt vmcnt(6)
    buffer_load_dwordx4 v2, s[48:51], s67 offen offset:0 nt lds
    s_waitcnt vmcnt(6)
    buffer_load_dwordx4 v2, s[48:51], s67 offen offset:1024 nt lds
    s_waitcnt vmcnt(6)
    buffer_load_dwordx4 v2, s[48:51], s67 offen offset:2048 nt lds
    s_waitcnt vmcnt(6)
    buffer_load_dwordx4 v2, s[48:51], s67 offen offset:3072 nt lds
    s_add_u32 s67, s8, s21
    s_add_u32 m0, s66, 20480
    s_waitcnt vmcnt(6)
    buffer_load_dwordx4 v2, s[48:51], s67 offen offset:0 nt lds
    s_waitcnt vmcnt(6)
    buffer_load_dwordx4 v2, s[48:51], s67 offen offset:1024 nt lds
    s_waitcnt vmcnt(6)
    buffer_load_dwordx4 v2, s[48:51], s67 offen offset:2048 nt lds
    s_waitcnt vmcnt(6)
    buffer_load_dwordx4 v2, s[48:51], s67 offen offset:3072 nt lds
    s_add_u32 s6, s6, 1
    s_mov_b32 s7, s8
    s_add_u32 s10, s10, 741376
    s_add_u32 s11, s11, 741376
    s_add_u32 s36, s36, 741376
    s_branch L_J
L_COMM:
    s_waitcnt lgkmcnt(0)
    s_mov_b32 s80, s40
    s_and_b32 s81, s41, 0xffff
    s_mov_b32 s82, 0xd00000
    s_mov_b32 s83, 0x20000
    s_mov_b32 s84, s38
    s_nop 0
    s_and_b32 s85, s39, 0xffff
    s_mov_b32 s86, 256
    s_mov_b32 s87, 0x20000
    s_mov_b32 s78, 0x05040100
    s_mov_b32 s77, 0x07060302
    s_mov_b32 s92, s36
    s_and_b32 s93, s37, 0xffff
    s_mov_b32 s94, 5120
    s_mov_b32 s95, 0x20000
    v_lshlrev_b32 v11, 2, v47
    v_lshlrev_b32 v17, 4, v47
    v_lshrrev_b32 v44, 2, v47
    v_lshlrev_b32 v44, 13, v44
    v_and_b32_e64 v43, 3, v47
    v_lshl_add_u32 v44, v43, 4, v44
    s_lshl_b32 s76, s3, 8
    s_lshl_b32 s64, s5, 6
    s_add_u32 s76, s76, s64
    s_mul_i32 s71, s5, 38912
    s_add_u32 s71, s71, 8192
    v_lshlrev_b32_e64 v48, 9, v45
    v_lshl_add_u32 v48, v46, 2, v48
    v_add_u32 v48, s71, v48
    s_andn2_b32 s73, s3, 3
    s_add_u32 s73, s73, s5
    s_and_b32 s72, s3, 3
    s_mul_i32 s43, s73, 4608
    s_mul_i32 s68, s5, 5120
    s_add_u32 s68, s68, 147456
    s_lshl_b32 s69, s76, 1
    s_add_u32 s69, s69, 167936
    s_mul_i32 s75, s72, 5120
    s_lshr_b32 s65, s3, 2
    s_mul_i32 s65, s65, 640
    s_add_u32 s75, s75, s65
    s_add_u32 s75, s75, 147456
    v_add_u32 v40, s75, v17
    v_subrev_u32 v41, 640, v17
    v_add_u32 v41, s69, v41
    v_cmp_gt_u32 vcc, 40, v47
    s_nop 1
    v_cndmask_b32 v40, v41, v40, vcc
    s_lshr_b32 s65, s3, 2
    s_lshl_b32 s65, s65, 7
    s_add_u32 s65, s65, 184320
    v_mov_b32 v41, s65
    v_cmp_gt_u32 vcc, 44, v47
    s_nop 1
    v_cndmask_b32 v40, v41, v40, vcc
    v_mov_b32 v36, -1
    v_mov_b32 v37, -1
    v_mov_b32 v38, -1
    v_mov_b32_e64 v39, -1
    s_mov_b32 exec_hi, 0x1fff
    s_mov_b32 s64, 0
    buffer_store_dwordx4 v[36:39], v40, s[80:83], s64 offen sc1
    s_mov_b32 s64, 185344
    buffer_store_dwordx4 v[36:39], v40, s[80:83], s64 offen sc1
    s_mov_b32 s64, 370688
    buffer_store_dwordx4 v[36:39], v40, s[80:83], s64 offen sc1
    s_mov_b32 s64, 556032
    buffer_store_dwordx4 v[36:39], v40, s[80:83], s64 offen sc1
    s_mov_b32 s64, 741376
    buffer_store_dwordx4 v[36:39], v40, s[80:83], s64 offen sc1
    s_mov_b32 s64, 926720
    buffer_store_dwordx4 v[36:39], v40, s[80:83], s64 offen sc1
    s_mov_b32 s64, 1112064
    buffer_store_dwordx4 v[36:39], v40, s[80:83], s64 offen sc1
    s_mov_b32 s64, 1297408
    buffer_store_dwordx4 v[36:39], v40, s[80:83], s64 offen sc1
    s_mov_b32 s64, 1482752
    buffer_store_dwordx4 v[36:39], v40, s[80:83], s64 offen sc1
    s_mov_b32 s64, 1668096
    buffer_store_dwordx4 v[36:39], v40, s[80:83], s64 offen sc1
    s_mov_b32 s64, 1853440
    buffer_store_dwordx4 v[36:39], v40, s[80:83], s64 offen sc1
    s_mov_b32 s64, 2038784
    buffer_store_dwordx4 v[36:39], v40, s[80:83], s64 offen sc1
    s_mov_b32 s64, 2224128
    buffer_store_dwordx4 v[36:39], v40, s[80:83], s64 offen sc1
    s_mov_b32 s64, 2409472
    buffer_store_dwordx4 v[36:39], v40, s[80:83], s64 offen sc1
    s_mov_b32 s64, 2594816
    buffer_store_dwordx4 v[36:39], v40, s[80:83], s64 offen sc1
    s_mov_b32 s64, 2780160
    buffer_store_dwordx4 v[36:39], v40, s[80:83], s64 offen sc1
    s_mov_b64 exec, -1
    s_mov_b32 s88, s16
    s_and_b32 s89, s17, 0xffff
    s_mov_b32 s90, 5120
    s_mov_b32 s91, 0x20000
    s_mul_i32 s64, s5, 1280
    buffer_load_dword v20, v11, s[88:91], s64 offen offset:0
    buffer_load_dword v21, v11, s[88:91], s64 offen offset:256
    buffer_load_dword v22, v11, s[88:91], s64 offen offset:512
    buffer_load_dword v23, v11, s[88:91], s64 offen offset:768
    buffer_load_dword v24, v11, s[88:91], s64 offen offset:1024
    s_mov_b32 s44, s22
    s_and_b32 s45, s23, 0xffff
    s_mov_b32 s46, 0x500000
    s_mov_b32 s47, 0x20000
    s_mov_b32 s48, s32
    s_and_b32 s49, s33, 0xffff
    s_mov_b32 s50, 0x500000
    s_mov_b32 s51, 0x20000
    s_mov_b32 s52, s24
    s_and_b32 s53, s25, 0xffff
    s_mov_b32 s54, 0x500000
    s_mov_b32 s55, 0x20000
    s_mov_b32 s56, s34
    s_and_b32 s57, s35, 0xffff
    s_mov_b32 s58, 0x500000
    s_mov_b32 s59, 0x20000
    v_lshlrev_b32 v1, 3, v47
    v_and_b32 v43, 7, v47
    v_cmp_eq_u32 vcc, 7, v43
    v_min_u32 v43, 6, v43
    v_lshlrev_b32_e64 v2, 7, v43
    v_add_u32 v2, 3584, v2
    v_cndmask_b32 v3, 1.0, 0, vcc
    v_mul_u32_u24 v43, 1280, v45
    v_lshl_add_u32 v4, v46, 4, v43
    v_lshl_add_u32 v5, v46, 3, v43
    v_add_u32 v5, 512, v5
    s_mul_i32 s65, s5, 640
    s_add_u32 s65, s65, 5120
    v_add_u32 v6, s65, v11
    v_add_u32 v18, s65, v17
    v_add_u32 v19, s65, v1
    v_lshlrev_b32 v10, 4, v45
    v_add_u32_e64 v7, s65, v10
    s_mul_i32 s65, s5, 320
    v_lshlrev_b32 v8, 4, v46
    v_and_b32 v43, 1, v45
    v_lshl_add_u32 v8, v43, 2, v8
    v_lshrrev_b32_e64 v43, 1, v45
    v_lshl_add_u32 v8, v43, 1, v8
    v_add_u32 v8, s65, v8
    v_lshlrev_b32 v9, 2, v46
    v_lshl_add_u32 v9, v43, 1, v9
    s_add_u32 s65, s65, 256
    v_add_u32 v9, s65, v9
    v_add_u32 v16, s71, v17
    s_mul_i32 s42, s73, 163840
    s_mul_i32 s65, s72, 320
    s_add_u32 s42, s42, s65
    s_movk_i32 s74, 560
    s_movk_i32 s70, 640
    v_mov_b32 v12, 0
    v_mov_b32 v13, 0
    v_mov_b32 v14, 0
    v_mov_b32 v15, 0
    s_waitcnt vmcnt(0)
    s_mul_i32 s65, s5, 1280
    v_add_u32_e64 v43, s65, v11
    v_mov_b32 v42, 0x3f803f80
    ds_write_b32 v43, v20 offset:0
    ds_write_b32 v11, v42 offset:5120
    ds_write_b32 v43, v21 offset:256
    ds_write_b32 v11, v42 offset:5376
    ds_write_b32 v43, v22 offset:512
    ds_write_b32 v11, v42 offset:5632
    ds_write_b32 v43, v23 offset:768
    ds_write_b32 v11, v42 offset:5888
    ds_write_b32 v43, v24 offset:1024
    ds_write_b32 v11, v42 offset:6144
    s_waitcnt lgkmcnt(0)
    s_barrier
    s_cmp_lg_u32 s5, 0
    s_cbranch_scc1 L_CNF
    s_lshr_b32 s65, s3, 2
    s_lshl_b32 s65, s65, 5
    v_mov_b32 v42, s99
    s_mov_b64 exec, 1
    buffer_atomic_add v42, v11, s[84:87], s65 offen offset:4 sc1
    s_mov_b64 exec, -1
L_CNF:
    s_add_u32 s64, s76, 0
    s_add_u32 m0, s71, 0
    s_nop 0
    buffer_load_dwordx4 v44, s[44:47], s64 offen lds
    s_add_u32 s64, s76, 131072
    s_add_u32 m0, s71, 1024
    v_nop_e64
    buffer_load_dwordx4 v44, s[44:47], s64 offen lds
    s_add_u32 s64, s76, 262144
    s_add_u32 m0, s71, 2048
    v_nop_e64
    buffer_load_dwordx4 v44, s[44:47], s64 offen lds
    s_add_u32 s64, s76, 393216
    s_add_u32 m0, s71, 3072
    v_nop_e64
    buffer_load_dwordx4 v44, s[44:47], s64 offen lds
    s_add_u32 s64, s76, 524288
    s_add_u32 m0, s71, 4096
    v_nop_e64
    buffer_load_dwordx4 v44, s[44:47], s64 offen lds
    s_add_u32 s64, s76, 655360
    s_add_u32 m0, s71, 5120
    v_nop_e64
    buffer_load_dwordx4 v44, s[44:47], s64 offen lds
    s_add_u32 s64, s76, 786432
    s_add_u32 m0, s71, 6144
    v_nop_e64
    buffer_load_dwordx4 v44, s[44:47], s64 offen lds
    s_add_u32 s64, s76, 917504
    s_add_u32 m0, s71, 7168
    v_nop_e64
    buffer_load_dwordx4 v44, s[44:47], s64 offen lds
    s_add_u32 s64, s76, 1048576
    s_add_u32 m0, s71, 8192
    v_nop_e64
    buffer_load_dwordx4 v44, s[44:47], s64 offen lds
    s_add_u32 s64, s76, 1179648
    s_add_u32 m0, s71, 9216
    v_nop_e64
    buffer_load_dwordx4 v44, s[44:47], s64 offen lds
    s_add_u32 s64, s76, 1310720
    s_add_u32 m0, s71, 10240
    v_nop_e64
    buffer_load_dwordx4 v44, s[44:47], s64 offen lds
    s_add_u32 s64, s76, 1441792
    s_add_u32 m0, s71, 11264
    v_nop_e64
    buffer_load_dwordx4 v44, s[44:47], s64 offen lds
    s_add_u32 s64, s76, 1572864
    s_add_u32 m0, s71, 12288
    v_nop_e64
    buffer_load_dwordx4 v44, s[44:47], s64 offen lds
    s_add_u32 s64, s76, 1703936
    s_add_u32 m0, s71, 13312
    v_nop_e64
    buffer_load_dwordx4 v44, s[44:47], s64 offen lds
    s_add_u32 s64, s76, 1835008
    s_add_u32 m0, s71, 14336
    v_nop_e64
    buffer_load_dwordx4 v44, s[44:47], s64 offen lds
    s_add_u32 s64, s76, 1966080
    s_add_u32 m0, s71, 15360
    v_nop_e64
    buffer_load_dwordx4 v44, s[44:47], s64 offen lds
    s_add_u32 s64, s76, 2097152
    s_add_u32 m0, s71, 16384
    v_nop_e64
    buffer_load_dwordx4 v44, s[44:47], s64 offen lds
    s_add_u32 s64, s76, 2228224
    s_add_u32 m0, s71, 17408
    v_nop_e64
    buffer_load_dwordx4 v44, s[44:47], s64 offen lds
    s_add_u32 s64, s76, 2359296
    s_add_u32 m0, s71, 18432
    v_nop_e64
    buffer_load_dwordx4 v44, s[44:47], s64 offen lds
    s_add_u32 s64, s76, 2490368
    s_add_u32 m0, s71, 19456
    v_nop_e64
    buffer_load_dwordx4 v44, s[44:47], s64 offen lds
    s_add_u32 s64, s76, 2621440
    s_add_u32 m0, s71, 20480
    v_nop_e64
    buffer_load_dwordx4 v44, s[44:47], s64 offen lds
    s_add_u32 s64, s76, 2752512
    s_add_u32 m0, s71, 21504
    v_nop_e64
    buffer_load_dwordx4 v44, s[44:47], s64 offen lds
    s_add_u32 s64, s76, 2883584
    s_add_u32 m0, s71, 22528
    v_nop_e64
    buffer_load_dwordx4 v44, s[44:47], s64 offen lds
    s_add_u32 s64, s76, 3014656
    s_add_u32 m0, s71, 23552
    v_nop_e64
    buffer_load_dwordx4 v44, s[44:47], s64 offen lds
    s_add_u32 s64, s76, 3145728
    s_add_u32 m0, s71, 24576
    v_nop_e64
    buffer_load_dwordx4 v44, s[44:47], s64 offen lds
    s_add_u32 s64, s76, 3276800
    s_add_u32 m0, s71, 25600
    v_nop_e64
    buffer_load_dwordx4 v44, s[44:47], s64 offen lds
    s_add_u32 s64, s76, 3407872
    s_add_u32 m0, s71, 26624
    v_nop_e64
    buffer_load_dwordx4 v44, s[44:47], s64 offen lds
    s_add_u32 s64, s76, 3538944
    s_add_u32 m0, s71, 27648
    v_nop_e64
    buffer_load_dwordx4 v44, s[44:47], s64 offen lds
    s_add_u32 s64, s76, 3670016
    s_add_u32 m0, s71, 28672
    v_nop_e64
    buffer_load_dwordx4 v44, s[44:47], s64 offen lds
    s_add_u32 s64, s76, 3801088
    s_add_u32 m0, s71, 29696
    v_nop_e64
    buffer_load_dwordx4 v44, s[44:47], s64 offen lds
    v_mad_u32_u24 v40, v10, s74, v4
    v_and_b32_e64 v41, 63, v11
    v_add_u32 v41, 256, v41
    v_mad_u32_u24 v41, v10, s70, v41
    s_waitcnt vmcnt(20)
    v_add_u32 v49, 0, v48
    ds_read2_b32 v[52:53], v49 offset0:0 offset1:16
    ds_read2_b32 v[54:55], v49 offset0:32 offset1:48
    ds_read2_b32 v[56:57], v49 offset0:64 offset1:80
    ds_read2_b32 v[58:59], v49 offset0:96 offset1:112
    v_add_u32 v49, 2048, v48
    ds_read2_b32 v[60:61], v49 offset0:0 offset1:16
    ds_read2_b32 v[62:63], v49 offset0:32 offset1:48
    ds_read2_b32 v[64:65], v49 offset0:64 offset1:80
    ds_read2_b32 v[66:67], v49 offset0:96 offset1:112
    v_add_u32 v49, 4096, v48
    ds_read2_b32 v[68:69], v49 offset0:0 offset1:16
    ds_read2_b32 v[70:71], v49 offset0:32 offset1:48
    ds_read2_b32 v[72:73], v49 offset0:64 offset1:80
    ds_read2_b32 v[74:75], v49 offset0:96 offset1:112
    s_waitcnt lgkmcnt(6)
    s_nop 0
    v_add_u32 v49, 6144, v48
    ds_read2_b32 v[76:77], v49 offset0:0 offset1:16
    ds_read2_b32 v[78:79], v49 offset0:32 offset1:48
    ds_read2_b32 v[80:81], v49 offset0:64 offset1:80
    ds_read2_b32 v[82:83], v49 offset0:96 offset1:112
    v_add_u32 v49, 8192, v48
    ds_read2_b32 v[84:85], v49 offset0:0 offset1:16
    ds_read2_b32 v[86:87], v49 offset0:32 offset1:48
    ds_read2_b32 v[88:89], v49 offset0:64 offset1:80
    ds_read2_b32 v[90:91], v49 offset0:96 offset1:112
    s_waitcnt lgkmcnt(15)
    s_nop 0
    v_perm_b32 v92, v53, v52, s78
    v_accvgpr_write_b32 a0, v92
    v_perm_b32 v93, v55, v54, s78
    v_accvgpr_write_b32 a1, v93
    v_perm_b32 v94, v57, v56, s78
    v_accvgpr_write_b32 a2, v94
    v_perm_b32 v95, v59, v58, s78
    v_accvgpr_write_b32 a3, v95
    v_perm_b32 v92, v53, v52, s77
    v_accvgpr_write_b32 a4, v92
    v_perm_b32 v93, v55, v54, s77
    v_accvgpr_write_b32 a5, v93
    v_perm_b32 v94, v57, v56, s77
    v_accvgpr_write_b32 a6, v94
    v_perm_b32 v95, v59, v58, s77
    v_accvgpr_write_b32 a7, v95
    s_waitcnt lgkmcnt(12)
    s_nop 0
    v_perm_b32 v92, v61, v60, s78
    v_accvgpr_write_b32 a8, v92
    v_perm_b32 v93, v63, v62, s78
    v_accvgpr_write_b32 a9, v93
    v_perm_b32 v94, v65, v64, s78
    v_accvgpr_write_b32 a10, v94
    v_perm_b32 v95, v67, v66, s78
    v_accvgpr_write_b32 a11, v95
    v_perm_b32 v92, v61, v60, s77
    v_accvgpr_write_b32 a12, v92
    v_perm_b32 v93, v63, v62, s77
    v_accvgpr_write_b32 a13, v93
    v_perm_b32 v94, v65, v64, s77
    v_accvgpr_write_b32 a14, v94
    v_perm_b32 v95, v67, v66, s77
    v_accvgpr_write_b32 a15, v95
    s_waitcnt lgkmcnt(8)
    s_nop 0
    v_perm_b32 v92, v69, v68, s78
    v_accvgpr_write_b32 a16, v92
    v_perm_b32 v93, v71, v70, s78
    v_accvgpr_write_b32 a17, v93
    v_perm_b32 v94, v73, v72, s78
    v_accvgpr_write_b32 a18, v94
    v_perm_b32 v95, v75, v74, s78
    v_accvgpr_write_b32 a19, v95
    v_perm_b32 v92, v69, v68, s77
    v_accvgpr_write_b32 a20, v92
    v_perm_b32 v93, v71, v70, s77
    v_accvgpr_write_b32 a21, v93
    v_perm_b32 v94, v73, v72, s77
    v_accvgpr_write_b32 a22, v94
    v_perm_b32 v95, v75, v74, s77
    v_accvgpr_write_b32 a23, v95
    s_waitcnt lgkmcnt(4)
    s_nop 0
    v_perm_b32 v92, v77, v76, s78
    v_accvgpr_write_b32 a24, v92
    v_perm_b32 v93, v79, v78, s78
    v_accvgpr_write_b32 a25, v93
    v_perm_b32 v94, v81, v80, s78
    v_accvgpr_write_b32 a26, v94
    v_perm_b32 v95, v83, v82, s78
    v_accvgpr_write_b32 a27, v95
    v_perm_b32 v92, v77, v76, s77
    v_accvgpr_write_b32 a28, v92
    v_perm_b32 v93, v79, v78, s77
    v_accvgpr_write_b32 a29, v93
    v_perm_b32 v94, v81, v80, s77
    v_accvgpr_write_b32 a30, v94
    v_perm_b32 v95, v83, v82, s77
    v_accvgpr_write_b32 a31, v95
    s_waitcnt lgkmcnt(0)
    s_nop 0
    v_perm_b32 v92, v85, v84, s78
    v_accvgpr_write_b32 a32, v92
    v_perm_b32 v93, v87, v86, s78
    v_accvgpr_write_b32 a33, v93
    v_perm_b32 v94, v89, v88, s78
    v_accvgpr_write_b32 a34, v94
    v_perm_b32 v95, v91, v90, s78
    v_accvgpr_write_b32 a35, v95
    v_perm_b32 v92, v85, v84, s77
    v_accvgpr_write_b32 a36, v92
    v_perm_b32 v93, v87, v86, s77
    v_accvgpr_write_b32 a37, v93
    v_perm_b32 v94, v89, v88, s77
    v_accvgpr_write_b32 a38, v94
    v_perm_b32 v95, v91, v90, s77
    v_accvgpr_write_b32 a39, v95
    s_add_u32 s64, s76, 3932160
    s_add_u32 m0, s71, 0
    s_nop 0
    buffer_load_dwordx4 v44, s[44:47], s64 offen lds
    s_add_u32 s64, s76, 4063232
    s_add_u32 m0, s71, 1024
    v_nop_e64
    buffer_load_dwordx4 v44, s[44:47], s64 offen lds
    s_add_u32 s64, s76, 4194304
    s_add_u32 m0, s71, 2048
    v_nop_e64
    buffer_load_dwordx4 v44, s[44:47], s64 offen lds
    s_add_u32 s64, s76, 4325376
    s_add_u32 m0, s71, 3072
    v_nop_e64
    buffer_load_dwordx4 v44, s[44:47], s64 offen lds
    s_add_u32 s64, s76, 4456448
    s_add_u32 m0, s71, 4096
    v_nop_e64
    buffer_load_dwordx4 v44, s[44:47], s64 offen lds
    s_add_u32 s64, s76, 4587520
    s_add_u32 m0, s71, 5120
    v_nop_e64
    buffer_load_dwordx4 v44, s[44:47], s64 offen lds
    s_add_u32 s64, s76, 4718592
    s_add_u32 m0, s71, 6144
    v_nop_e64
    buffer_load_dwordx4 v44, s[44:47], s64 offen lds
    s_add_u32 s64, s76, 4849664
    s_add_u32 m0, s71, 7168
    v_nop_e64
    buffer_load_dwordx4 v44, s[44:47], s64 offen lds
    s_add_u32 s64, s76, 4980736
    s_add_u32 m0, s71, 8192
    v_nop_e64
    buffer_load_dwordx4 v44, s[44:47], s64 offen lds
    s_add_u32 s64, s76, 5111808
    s_add_u32 m0, s71, 9216
    v_nop_e64
    buffer_load_dwordx4 v44, s[44:47], s64 offen lds
    s_add_u32 s64, s42, 40960
    buffer_load_dwordx4 v[108:111], v40, s[52:55], s64 offen offset:0
    buffer_load_dword v140, v41, s[52:55], s64 offen offset:0
    buffer_load_dwordx4 v[112:115], v40, s[52:55], s64 offen offset:1280
    buffer_load_dword v141, v41, s[52:55], s64 offen offset:1280
    buffer_load_dwordx4 v[116:119], v40, s[52:55], s64 offen offset:2560
    buffer_load_dword v142, v41, s[52:55], s64 offen offset:2560
    buffer_load_dwordx4 v[120:123], v40, s[52:55], s64 offen offset:3840
    buffer_load_dword v143, v41, s[52:55], s64 offen offset:3840
    s_add_u32 s64, s42, 46080
    buffer_load_dwordx4 v[124:127], v40, s[52:55], s64 offen offset:0
    buffer_load_dword v144, v41, s[52:55], s64 offen offset:0
    buffer_load_dwordx4 v[128:131], v40, s[52:55], s64 offen offset:1280
    buffer_load_dword v145, v41, s[52:55], s64 offen offset:1280
    buffer_load_dwordx4 v[132:135], v40, s[52:55], s64 offen offset:2560
    buffer_load_dword v146, v41, s[52:55], s64 offen offset:2560
    buffer_load_dwordx4 v[136:139], v40, s[52:55], s64 offen offset:3840
    buffer_load_dword v147, v41, s[52:55], s64 offen offset:3840
    s_add_u32 s64, s42, 122880
    buffer_load_dwordx4 v[148:151], v40, s[52:55], s64 offen offset:0
    buffer_load_dword v180, v41, s[52:55], s64 offen offset:0
    buffer_load_dwordx4 v[152:155], v40, s[52:55], s64 offen offset:1280
    buffer_load_dword v181, v41, s[52:55], s64 offen offset:1280
    buffer_load_dwordx4 v[156:159], v40, s[52:55], s64 offen offset:2560
    buffer_load_dword v182, v41, s[52:55], s64 offen offset:2560
    buffer_load_dwordx4 v[160:163], v40, s[52:55], s64 offen offset:3840
    buffer_load_dword v183, v41, s[52:55], s64 offen offset:3840
    s_add_u32 s64, s42, 128000
    buffer_load_dwordx4 v[164:167], v40, s[52:55], s64 offen offset:0
    buffer_load_dword v184, v41, s[52:55], s64 offen offset:0
    buffer_load_dwordx4 v[168:171], v40, s[52:55], s64 offen offset:1280
    buffer_load_dword v185, v41, s[52:55], s64 offen offset:1280
    buffer_load_dwordx4 v[172:175], v40, s[52:55], s64 offen offset:2560
    buffer_load_dword v186, v41, s[52:55], s64 offen offset:2560
    buffer_load_dwordx4 v[176:179], v40, s[52:55], s64 offen offset:3840
    buffer_load_dword v187, v41, s[52:55], s64 offen offset:3840
    s_waitcnt vmcnt(52)
    s_nop 0
    v_add_u32 v49, 10240, v48
    ds_read2_b32 v[52:53], v49 offset0:0 offset1:16
    ds_read2_b32 v[54:55], v49 offset0:32 offset1:48
    ds_read2_b32 v[56:57], v49 offset0:64 offset1:80
    ds_read2_b32 v[58:59], v49 offset0:96 offset1:112
    v_add_u32 v49, 12288, v48
    ds_read2_b32 v[60:61], v49 offset0:0 offset1:16
    ds_read2_b32 v[62:63], v49 offset0:32 offset1:48
    ds_read2_b32 v[64:65], v49 offset0:64 offset1:80
    ds_read2_b32 v[66:67], v49 offset0:96 offset1:112
    v_add_u32 v49, 14336, v48
    ds_read2_b32 v[68:69], v49 offset0:0 offset1:16
    ds_read2_b32 v[70:71], v49 offset0:32 offset1:48
    ds_read2_b32 v[72:73], v49 offset0:64 offset1:80
    ds_read2_b32 v[74:75], v49 offset0:96 offset1:112
    s_waitcnt lgkmcnt(6)
    s_nop 0
    v_add_u32 v49, 16384, v48
    ds_read2_b32 v[76:77], v49 offset0:0 offset1:16
    ds_read2_b32 v[78:79], v49 offset0:32 offset1:48
    ds_read2_b32 v[80:81], v49 offset0:64 offset1:80
    ds_read2_b32 v[82:83], v49 offset0:96 offset1:112
    v_add_u32 v49, 18432, v48
    ds_read2_b32 v[84:85], v49 offset0:0 offset1:16
    ds_read2_b32 v[86:87], v49 offset0:32 offset1:48
    ds_read2_b32 v[88:89], v49 offset0:64 offset1:80
    ds_read2_b32 v[90:91], v49 offset0:96 offset1:112
    s_waitcnt lgkmcnt(15)
    s_nop 0
    v_perm_b32 v92, v53, v52, s78
    v_accvgpr_write_b32 a40, v92
    v_perm_b32 v93, v55, v54, s78
    v_accvgpr_write_b32 a41, v93
    v_perm_b32 v94, v57, v56, s78
    v_accvgpr_write_b32 a42, v94
    v_perm_b32 v95, v59, v58, s78
    v_accvgpr_write_b32 a43, v95
    v_perm_b32 v92, v53, v52, s77
    v_accvgpr_write_b32 a44, v92
    v_perm_b32 v93, v55, v54, s77
    v_accvgpr_write_b32 a45, v93
    v_perm_b32 v94, v57, v56, s77
    v_accvgpr_write_b32 a46, v94
    v_perm_b32 v95, v59, v58, s77
    v_accvgpr_write_b32 a47, v95
    s_waitcnt lgkmcnt(12)
    s_nop 0
    v_perm_b32 v92, v61, v60, s78
    v_accvgpr_write_b32 a48, v92
    v_perm_b32 v93, v63, v62, s78
    v_accvgpr_write_b32 a49, v93
    v_perm_b32 v94, v65, v64, s78
    v_accvgpr_write_b32 a50, v94
    v_perm_b32 v95, v67, v66, s78
    v_accvgpr_write_b32 a51, v95
    v_perm_b32 v92, v61, v60, s77
    v_accvgpr_write_b32 a52, v92
    v_perm_b32 v93, v63, v62, s77
    v_accvgpr_write_b32 a53, v93
    v_perm_b32 v94, v65, v64, s77
    v_accvgpr_write_b32 a54, v94
    v_perm_b32 v95, v67, v66, s77
    v_accvgpr_write_b32 a55, v95
    s_waitcnt lgkmcnt(8)
    s_nop 0
    v_perm_b32 v92, v69, v68, s78
    v_accvgpr_write_b32 a56, v92
    v_perm_b32 v93, v71, v70, s78
    v_accvgpr_write_b32 a57, v93
    v_perm_b32 v94, v73, v72, s78
    v_accvgpr_write_b32 a58, v94
    v_perm_b32 v95, v75, v74, s78
    v_accvgpr_write_b32 a59, v95
    v_perm_b32 v92, v69, v68, s77
    v_accvgpr_write_b32 a60, v92
    v_perm_b32 v93, v71, v70, s77
    v_accvgpr_write_b32 a61, v93
    v_perm_b32 v94, v73, v72, s77
    v_accvgpr_write_b32 a62, v94
    v_perm_b32 v95, v75, v74, s77
    v_accvgpr_write_b32 a63, v95
    s_waitcnt lgkmcnt(4)
    s_nop 0
    v_perm_b32 v92, v77, v76, s78
    v_accvgpr_write_b32 a64, v92
    v_perm_b32 v93, v79, v78, s78
    v_accvgpr_write_b32 a65, v93
    v_perm_b32 v94, v81, v80, s78
    v_accvgpr_write_b32 a66, v94
    v_perm_b32 v95, v83, v82, s78
    v_accvgpr_write_b32 a67, v95
    v_perm_b32 v92, v77, v76, s77
    v_accvgpr_write_b32 a68, v92
    v_perm_b32 v93, v79, v78, s77
    v_accvgpr_write_b32 a69, v93
    v_perm_b32 v94, v81, v80, s77
    v_accvgpr_write_b32 a70, v94
    v_perm_b32 v95, v83, v82, s77
    v_accvgpr_write_b32 a71, v95
    s_waitcnt lgkmcnt(0)
    s_nop 0
    v_perm_b32 v92, v85, v84, s78
    v_accvgpr_write_b32 a72, v92
    v_perm_b32 v93, v87, v86, s78
    v_accvgpr_write_b32 a73, v93
    v_perm_b32 v94, v89, v88, s78
    v_accvgpr_write_b32 a74, v94
    v_perm_b32 v95, v91, v90, s78
    v_accvgpr_write_b32 a75, v95
    v_perm_b32 v92, v85, v84, s77
    v_accvgpr_write_b32 a76, v92
    v_perm_b32 v93, v87, v86, s77
    v_accvgpr_write_b32 a77, v93
    v_perm_b32 v94, v89, v88, s77
    v_accvgpr_write_b32 a78, v94
    v_perm_b32 v95, v91, v90, s77
    v_accvgpr_write_b32 a79, v95
    s_add_u32 s64, s76, 0
    s_add_u32 m0, s71, 10240
    s_nop 0
    buffer_load_dwordx4 v44, s[48:51], s64 offen lds
    s_add_u32 s64, s76, 131072
    s_add_u32 m0, s71, 11264
    v_nop_e64
    buffer_load_dwordx4 v44, s[48:51], s64 offen lds
    s_add_u32 s64, s76, 262144
    s_add_u32 m0, s71, 12288
    v_nop_e64
    buffer_load_dwordx4 v44, s[48:51], s64 offen lds
    s_add_u32 s64, s76, 393216
    s_add_u32 m0, s71, 13312
    v_nop_e64
    buffer_load_dwordx4 v44, s[48:51], s64 offen lds
    s_add_u32 s64, s76, 524288
    s_add_u32 m0, s71, 14336
    v_nop_e64
    buffer_load_dwordx4 v44, s[48:51], s64 offen lds
    s_add_u32 s64, s76, 655360
    s_add_u32 m0, s71, 15360
    v_nop_e64
    buffer_load_dwordx4 v44, s[48:51], s64 offen lds
    s_add_u32 s64, s76, 786432
    s_add_u32 m0, s71, 16384
    v_nop_e64
    buffer_load_dwordx4 v44, s[48:51], s64 offen lds
    s_add_u32 s64, s76, 917504
    s_add_u32 m0, s71, 17408
    v_nop_e64
    buffer_load_dwordx4 v44, s[48:51], s64 offen lds
    s_add_u32 s64, s76, 1048576
    s_add_u32 m0, s71, 18432
    v_nop_e64
    buffer_load_dwordx4 v44, s[48:51], s64 offen lds
    s_add_u32 s64, s76, 1179648
    s_add_u32 m0, s71, 19456
    v_nop_e64
    buffer_load_dwordx4 v44, s[48:51], s64 offen lds
    s_waitcnt vmcnt(52)
    s_nop 0
    v_add_u32 v49, 20480, v48
    ds_read2_b32 v[52:53], v49 offset0:0 offset1:16
    ds_read2_b32 v[54:55], v49 offset0:32 offset1:48
    ds_read2_b32 v[56:57], v49 offset0:64 offset1:80
    ds_read2_b32 v[58:59], v49 offset0:96 offset1:112
    v_add_u32 v49, 22528, v48
    ds_read2_b32 v[60:61], v49 offset0:0 offset1:16
    ds_read2_b32 v[62:63], v49 offset0:32 offset1:48
    ds_read2_b32 v[64:65], v49 offset0:64 offset1:80
    ds_read2_b32 v[66:67], v49 offset0:96 offset1:112
    v_add_u32 v49, 24576, v48
    ds_read2_b32 v[68:69], v49 offset0:0 offset1:16
    ds_read2_b32 v[70:71], v49 offset0:32 offset1:48
    ds_read2_b32 v[72:73], v49 offset0:64 offset1:80
    ds_read2_b32 v[74:75], v49 offset0:96 offset1:112
    s_waitcnt lgkmcnt(6)
    s_nop 0
    v_add_u32 v49, 26624, v48
    ds_read2_b32 v[76:77], v49 offset0:0 offset1:16
    ds_read2_b32 v[78:79], v49 offset0:32 offset1:48
    ds_read2_b32 v[80:81], v49 offset0:64 offset1:80
    ds_read2_b32 v[82:83], v49 offset0:96 offset1:112
    v_add_u32 v49, 28672, v48
    ds_read2_b32 v[84:85], v49 offset0:0 offset1:16
    ds_read2_b32 v[86:87], v49 offset0:32 offset1:48
    ds_read2_b32 v[88:89], v49 offset0:64 offset1:80
    ds_read2_b32 v[90:91], v49 offset0:96 offset1:112
    s_waitcnt lgkmcnt(15)
    s_nop 0
    v_perm_b32 v92, v53, v52, s78
    v_accvgpr_write_b32 a80, v92
    v_perm_b32 v93, v55, v54, s78
    v_accvgpr_write_b32 a81, v93
    v_perm_b32 v94, v57, v56, s78
    v_accvgpr_write_b32 a82, v94
    v_perm_b32 v95, v59, v58, s78
    v_accvgpr_write_b32 a83, v95
    v_perm_b32 v92, v53, v52, s77
    v_accvgpr_write_b32 a84, v92
    v_perm_b32 v93, v55, v54, s77
    v_accvgpr_write_b32 a85, v93
    v_perm_b32 v94, v57, v56, s77
    v_accvgpr_write_b32 a86, v94
    v_perm_b32 v95, v59, v58, s77
    v_accvgpr_write_b32 a87, v95
    s_waitcnt lgkmcnt(12)
    s_nop 0
    v_perm_b32 v92, v61, v60, s78
    v_accvgpr_write_b32 a88, v92
    v_perm_b32 v93, v63, v62, s78
    v_accvgpr_write_b32 a89, v93
    v_perm_b32 v94, v65, v64, s78
    v_accvgpr_write_b32 a90, v94
    v_perm_b32 v95, v67, v66, s78
    v_accvgpr_write_b32 a91, v95
    v_perm_b32 v92, v61, v60, s77
    v_accvgpr_write_b32 a92, v92
    v_perm_b32 v93, v63, v62, s77
    v_accvgpr_write_b32 a93, v93
    v_perm_b32 v94, v65, v64, s77
    v_accvgpr_write_b32 a94, v94
    v_perm_b32 v95, v67, v66, s77
    v_accvgpr_write_b32 a95, v95
    s_waitcnt lgkmcnt(8)
    s_nop 0
    v_perm_b32 v92, v69, v68, s78
    v_accvgpr_write_b32 a96, v92
    v_perm_b32 v93, v71, v70, s78
    v_accvgpr_write_b32 a97, v93
    v_perm_b32 v94, v73, v72, s78
    v_accvgpr_write_b32 a98, v94
    v_perm_b32 v95, v75, v74, s78
    v_accvgpr_write_b32 a99, v95
    v_perm_b32 v92, v69, v68, s77
    v_accvgpr_write_b32 a100, v92
    v_perm_b32 v93, v71, v70, s77
    v_accvgpr_write_b32 a101, v93
    v_perm_b32 v94, v73, v72, s77
    v_accvgpr_write_b32 a102, v94
    v_perm_b32 v95, v75, v74, s77
    v_accvgpr_write_b32 a103, v95
    s_waitcnt lgkmcnt(4)
    s_nop 0
    v_perm_b32 v92, v77, v76, s78
    v_accvgpr_write_b32 a104, v92
    v_perm_b32 v93, v79, v78, s78
    v_accvgpr_write_b32 a105, v93
    v_perm_b32 v94, v81, v80, s78
    v_accvgpr_write_b32 a106, v94
    v_perm_b32 v95, v83, v82, s78
    v_accvgpr_write_b32 a107, v95
    v_perm_b32 v92, v77, v76, s77
    v_accvgpr_write_b32 a108, v92
    v_perm_b32 v93, v79, v78, s77
    v_accvgpr_write_b32 a109, v93
    v_perm_b32 v94, v81, v80, s77
    v_accvgpr_write_b32 a110, v94
    v_perm_b32 v95, v83, v82, s77
    v_accvgpr_write_b32 a111, v95
    s_waitcnt lgkmcnt(0)
    s_nop 0
    v_perm_b32 v92, v85, v84, s78
    v_accvgpr_write_b32 a112, v92
    v_perm_b32 v93, v87, v86, s78
    v_accvgpr_write_b32 a113, v93
    v_perm_b32 v94, v89, v88, s78
    v_accvgpr_write_b32 a114, v94
    v_perm_b32 v95, v91, v90, s78
    v_accvgpr_write_b32 a115, v95
    v_perm_b32 v92, v85, v84, s77
    v_accvgpr_write_b32 a116, v92
    v_perm_b32 v93, v87, v86, s77
    v_accvgpr_write_b32 a117, v93
    v_perm_b32 v94, v89, v88, s77
    v_accvgpr_write_b32 a118, v94
    v_perm_b32 v95, v91, v90, s77
    v_accvgpr_write_b32 a119, v95
    s_add_u32 s64, s76, 1310720
    s_add_u32 m0, s71, 20480
    v_nop_e64
    buffer_load_dwordx4 v44, s[48:51], s64 offen lds
    s_add_u32 s64, s76, 1441792
    s_add_u32 m0, s71, 21504
    v_nop_e64
    buffer_load_dwordx4 v44, s[48:51], s64 offen lds
    s_add_u32 s64, s76, 1572864
    s_add_u32 m0, s71, 22528
    v_nop_e64
    buffer_load_dwordx4 v44, s[48:51], s64 offen lds
    s_add_u32 s64, s76, 1703936
    s_add_u32 m0, s71, 23552
    v_nop_e64
    buffer_load_dwordx4 v44, s[48:51], s64 offen lds
    s_add_u32 s64, s76, 1835008
    s_add_u32 m0, s71, 24576
    v_nop_e64
    buffer_load_dwordx4 v44, s[48:51], s64 offen lds
    s_add_u32 s64, s76, 1966080
    s_add_u32 m0, s71, 25600
    v_nop_e64
    buffer_load_dwordx4 v44, s[48:51], s64 offen lds
    s_add_u32 s64, s76, 2097152
    s_add_u32 m0, s71, 26624
    v_nop_e64
    buffer_load_dwordx4 v44, s[48:51], s64 offen lds
    s_add_u32 s64, s76, 2228224
    s_add_u32 m0, s71, 27648
    v_nop_e64
    buffer_load_dwordx4 v44, s[48:51], s64 offen lds
    s_add_u32 s64, s76, 2359296
    s_add_u32 m0, s71, 28672
    v_nop_e64
    buffer_load_dwordx4 v44, s[48:51], s64 offen lds
    s_add_u32 s64, s76, 2490368
    s_add_u32 m0, s71, 29696
    v_nop_e64
    buffer_load_dwordx4 v44, s[48:51], s64 offen lds
    s_waitcnt vmcnt(52)
    v_add_u32 v49, 0, v48
    ds_read2_b32 v[52:53], v49 offset0:0 offset1:16
    ds_read2_b32 v[54:55], v49 offset0:32 offset1:48
    ds_read2_b32 v[56:57], v49 offset0:64 offset1:80
    ds_read2_b32 v[58:59], v49 offset0:96 offset1:112
    v_add_u32 v49, 2048, v48
    ds_read2_b32 v[60:61], v49 offset0:0 offset1:16
    ds_read2_b32 v[62:63], v49 offset0:32 offset1:48
    ds_read2_b32 v[64:65], v49 offset0:64 offset1:80
    ds_read2_b32 v[66:67], v49 offset0:96 offset1:112
    v_add_u32 v49, 4096, v48
    ds_read2_b32 v[68:69], v49 offset0:0 offset1:16
    ds_read2_b32 v[70:71], v49 offset0:32 offset1:48
    ds_read2_b32 v[72:73], v49 offset0:64 offset1:80
    ds_read2_b32 v[74:75], v49 offset0:96 offset1:112
    s_waitcnt lgkmcnt(6)
    s_nop 0
    v_add_u32 v49, 6144, v48
    ds_read2_b32 v[76:77], v49 offset0:0 offset1:16
    ds_read2_b32 v[78:79], v49 offset0:32 offset1:48
    ds_read2_b32 v[80:81], v49 offset0:64 offset1:80
    ds_read2_b32 v[82:83], v49 offset0:96 offset1:112
    v_add_u32 v49, 8192, v48
    ds_read2_b32 v[84:85], v49 offset0:0 offset1:16
    ds_read2_b32 v[86:87], v49 offset0:32 offset1:48
    ds_read2_b32 v[88:89], v49 offset0:64 offset1:80
    ds_read2_b32 v[90:91], v49 offset0:96 offset1:112
    s_waitcnt lgkmcnt(15)
    s_nop 0
    v_perm_b32 v92, v53, v52, s78
    v_accvgpr_write_b32 a120, v92
    v_perm_b32 v93, v55, v54, s78
    v_accvgpr_write_b32 a121, v93
    v_perm_b32 v94, v57, v56, s78
    v_accvgpr_write_b32 a122, v94
    v_perm_b32 v95, v59, v58, s78
    v_accvgpr_write_b32 a123, v95
    v_perm_b32 v92, v53, v52, s77
    v_accvgpr_write_b32 a124, v92
    v_perm_b32 v93, v55, v54, s77
    v_accvgpr_write_b32 a125, v93
    v_perm_b32 v94, v57, v56, s77
    v_accvgpr_write_b32 a126, v94
    v_perm_b32 v95, v59, v58, s77
    v_accvgpr_write_b32 a127, v95
    s_waitcnt lgkmcnt(12)
    s_nop 0
    v_perm_b32 v92, v61, v60, s78
    v_accvgpr_write_b32 a128, v92
    v_perm_b32 v93, v63, v62, s78
    v_accvgpr_write_b32 a129, v93
    v_perm_b32 v94, v65, v64, s78
    v_accvgpr_write_b32 a130, v94
    v_perm_b32 v95, v67, v66, s78
    v_accvgpr_write_b32 a131, v95
    v_perm_b32 v92, v61, v60, s77
    v_accvgpr_write_b32 a132, v92
    v_perm_b32 v93, v63, v62, s77
    v_accvgpr_write_b32 a133, v93
    v_perm_b32 v94, v65, v64, s77
    v_accvgpr_write_b32 a134, v94
    v_perm_b32 v95, v67, v66, s77
    v_accvgpr_write_b32 a135, v95
    s_waitcnt lgkmcnt(8)
    s_nop 0
    v_perm_b32 v92, v69, v68, s78
    v_accvgpr_write_b32 a136, v92
    v_perm_b32 v93, v71, v70, s78
    v_accvgpr_write_b32 a137, v93
    v_perm_b32 v94, v73, v72, s78
    v_accvgpr_write_b32 a138, v94
    v_perm_b32 v95, v75, v74, s78
    v_accvgpr_write_b32 a139, v95
    v_perm_b32 v92, v69, v68, s77
    v_accvgpr_write_b32 a140, v92
    v_perm_b32 v93, v71, v70, s77
    v_accvgpr_write_b32 a141, v93
    v_perm_b32 v94, v73, v72, s77
    v_accvgpr_write_b32 a142, v94
    v_perm_b32 v95, v75, v74, s77
    v_accvgpr_write_b32 a143, v95
    s_waitcnt lgkmcnt(4)
    s_nop 0
    v_perm_b32 v92, v77, v76, s78
    v_accvgpr_write_b32 a144, v92
    v_perm_b32 v93, v79, v78, s78
    v_accvgpr_write_b32 a145, v93
    v_perm_b32 v94, v81, v80, s78
    v_accvgpr_write_b32 a146, v94
    v_perm_b32 v95, v83, v82, s78
    v_accvgpr_write_b32 a147, v95
    v_perm_b32 v92, v77, v76, s77
    v_accvgpr_write_b32 a148, v92
    v_perm_b32 v93, v79, v78, s77
    v_accvgpr_write_b32 a149, v93
    v_perm_b32 v94, v81, v80, s77
    v_accvgpr_write_b32 a150, v94
    v_perm_b32 v95, v83, v82, s77
    v_accvgpr_write_b32 a151, v95
    s_waitcnt lgkmcnt(0)
    s_nop 0
    v_perm_b32 v92, v85, v84, s78
    v_accvgpr_write_b32 a152, v92
    v_perm_b32 v93, v87, v86, s78
    v_accvgpr_write_b32 a153, v93
    v_perm_b32 v94, v89, v88, s78
    v_accvgpr_write_b32 a154, v94
    v_perm_b32 v95, v91, v90, s78
    v_accvgpr_write_b32 a155, v95
    v_perm_b32 v92, v85, v84, s77
    v_accvgpr_write_b32 a156, v92
    v_perm_b32 v93, v87, v86, s77
    v_accvgpr_write_b32 a157, v93
    v_perm_b32 v94, v89, v88, s77
    v_accvgpr_write_b32 a158, v94
    v_perm_b32 v95, v91, v90, s77
    v_accvgpr_write_b32 a159, v95
    s_add_u32 s64, s76, 2621440
    s_add_u32 m0, s71, 0
    s_nop 0
    buffer_load_dwordx4 v44, s[48:51], s64 offen lds
    s_add_u32 s64, s76, 2752512
    s_add_u32 m0, s71, 1024
    v_nop_e64
    buffer_load_dwordx4 v44, s[48:51], s64 offen lds
    s_add_u32 s64, s76, 2883584
    s_add_u32 m0, s71, 2048
    v_nop_e64
    buffer_load_dwordx4 v44, s[48:51], s64 offen lds
    s_add_u32 s64, s76, 3014656
    s_add_u32 m0, s71, 3072
    v_nop_e64
    buffer_load_dwordx4 v44, s[48:51], s64 offen lds
    s_add_u32 s64, s76, 3145728
    s_add_u32 m0, s71, 4096
    v_nop_e64
    buffer_load_dwordx4 v44, s[48:51], s64 offen lds
    s_add_u32 s64, s76, 3276800
    s_add_u32 m0, s71, 5120
    v_nop_e64
    buffer_load_dwordx4 v44, s[48:51], s64 offen lds
    s_add_u32 s64, s76, 3407872
    s_add_u32 m0, s71, 6144
    v_nop_e64
    buffer_load_dwordx4 v44, s[48:51], s64 offen lds
    s_add_u32 s64, s76, 3538944
    s_add_u32 m0, s71, 7168
    v_nop_e64
    buffer_load_dwordx4 v44, s[48:51], s64 offen lds
    s_add_u32 s64, s76, 3670016
    s_add_u32 m0, s71, 8192
    v_nop_e64
    buffer_load_dwordx4 v44, s[48:51], s64 offen lds
    s_add_u32 s64, s76, 3801088
    s_add_u32 m0, s71, 9216
    v_nop_e64
    buffer_load_dwordx4 v44, s[48:51], s64 offen lds
    s_mov_b32 s13, 1
    s_mov_b32 s12, 5120
    s_mov_b32 s14, 1
    s_add_u32 s11, s69, 0
    s_call_b64 s[100:101], R_WQ
    s_mov_b32 s13, 1
    s_mov_b32 s12, 0
    s_mov_b32 s14, 0
    s_add_u32 s11, s69, 0
    s_call_b64 s[100:101], R_WQ
    s_waitcnt vmcnt(20)
    v_add_u32 v49, 10240, v48
    ds_read2_b32 v[52:53], v49 offset0:0 offset1:16
    ds_read2_b32 v[54:55], v49 offset0:32 offset1:48
    ds_read2_b32 v[56:57], v49 offset0:64 offset1:80
    ds_read2_b32 v[58:59], v49 offset0:96 offset1:112
    v_add_u32 v49, 12288, v48
    ds_read2_b32 v[60:61], v49 offset0:0 offset1:16
    ds_read2_b32 v[62:63], v49 offset0:32 offset1:48
    ds_read2_b32 v[64:65], v49 offset0:64 offset1:80
    ds_read2_b32 v[66:67], v49 offset0:96 offset1:112
    v_add_u32 v49, 14336, v48
    ds_read2_b32 v[68:69], v49 offset0:0 offset1:16
    ds_read2_b32 v[70:71], v49 offset0:32 offset1:48
    ds_read2_b32 v[72:73], v49 offset0:64 offset1:80
    ds_read2_b32 v[74:75], v49 offset0:96 offset1:112
    s_waitcnt lgkmcnt(6)
    s_nop 0
    v_add_u32 v49, 16384, v48
    ds_read2_b32 v[76:77], v49 offset0:0 offset1:16
    ds_read2_b32 v[78:79], v49 offset0:32 offset1:48
    ds_read2_b32 v[80:81], v49 offset0:64 offset1:80
    ds_read2_b32 v[82:83], v49 offset0:96 offset1:112
    v_add_u32 v49, 18432, v48
    ds_read2_b32 v[84:85], v49 offset0:0 offset1:16
    ds_read2_b32 v[86:87], v49 offset0:32 offset1:48
    ds_read2_b32 v[88:89], v49 offset0:64 offset1:80
    ds_read2_b32 v[90:91], v49 offset0:96 offset1:112
    s_waitcnt lgkmcnt(15)
    s_nop 0
    v_perm_b32 v92, v53, v52, s78
    v_accvgpr_write_b32 a160, v92
    v_perm_b32 v93, v55, v54, s78
    v_accvgpr_write_b32 a161, v93
    v_perm_b32 v94, v57, v56, s78
    v_accvgpr_write_b32 a162, v94
    v_perm_b32 v95, v59, v58, s78
    v_accvgpr_write_b32 a163, v95
    v_perm_b32 v92, v53, v52, s77
    v_accvgpr_write_b32 a164, v92
    v_perm_b32 v93, v55, v54, s77
    v_accvgpr_write_b32 a165, v93
    v_perm_b32 v94, v57, v56, s77
    v_accvgpr_write_b32 a166, v94
    v_perm_b32 v95, v59, v58, s77
    v_accvgpr_write_b32 a167, v95
    s_waitcnt lgkmcnt(12)
    s_nop 0
    v_perm_b32 v92, v61, v60, s78
    v_accvgpr_write_b32 a168, v92
    v_perm_b32 v93, v63, v62, s78
    v_accvgpr_write_b32 a169, v93
    v_perm_b32 v94, v65, v64, s78
    v_accvgpr_write_b32 a170, v94
    v_perm_b32 v95, v67, v66, s78
    v_accvgpr_write_b32 a171, v95
    v_perm_b32 v92, v61, v60, s77
    v_accvgpr_write_b32 a172, v92
    v_perm_b32 v93, v63, v62, s77
    v_accvgpr_write_b32 a173, v93
    v_perm_b32 v94, v65, v64, s77
    v_accvgpr_write_b32 a174, v94
    v_perm_b32 v95, v67, v66, s77
    v_accvgpr_write_b32 a175, v95
    s_waitcnt lgkmcnt(8)
    s_nop 0
    v_perm_b32 v92, v69, v68, s78
    v_accvgpr_write_b32 a176, v92
    v_perm_b32 v93, v71, v70, s78
    v_accvgpr_write_b32 a177, v93
    v_perm_b32 v94, v73, v72, s78
    v_accvgpr_write_b32 a178, v94
    v_perm_b32 v95, v75, v74, s78
    v_accvgpr_write_b32 a179, v95
    v_perm_b32 v92, v69, v68, s77
    v_accvgpr_write_b32 a180, v92
    v_perm_b32 v93, v71, v70, s77
    v_accvgpr_write_b32 a181, v93
    v_perm_b32 v94, v73, v72, s77
    v_accvgpr_write_b32 a182, v94
    v_perm_b32 v95, v75, v74, s77
    v_accvgpr_write_b32 a183, v95
    s_waitcnt lgkmcnt(4)
    s_nop 0
    v_perm_b32 v92, v77, v76, s78
    v_accvgpr_write_b32 a184, v92
    v_perm_b32 v93, v79, v78, s78
    v_accvgpr_write_b32 a185, v93
    v_perm_b32 v94, v81, v80, s78
    v_accvgpr_write_b32 a186, v94
    v_perm_b32 v95, v83, v82, s78
    v_accvgpr_write_b32 a187, v95
    v_perm_b32 v92, v77, v76, s77
    v_accvgpr_write_b32 a188, v92
    v_perm_b32 v93, v79, v78, s77
    v_accvgpr_write_b32 a189, v93
    v_perm_b32 v94, v81, v80, s77
    v_accvgpr_write_b32 a190, v94
    v_perm_b32 v95, v83, v82, s77
    v_accvgpr_write_b32 a191, v95
    s_waitcnt lgkmcnt(0)
    s_nop 0
    v_perm_b32 v92, v85, v84, s78
    v_accvgpr_write_b32 a192, v92
    v_perm_b32 v93, v87, v86, s78
    v_accvgpr_write_b32 a193, v93
    v_perm_b32 v94, v89, v88, s78
    v_accvgpr_write_b32 a194, v94
    v_perm_b32 v95, v91, v90, s78
    v_accvgpr_write_b32 a195, v95
    v_perm_b32 v92, v85, v84, s77
    v_accvgpr_write_b32 a196, v92
    v_perm_b32 v93, v87, v86, s77
    v_accvgpr_write_b32 a197, v93
    v_perm_b32 v94, v89, v88, s77
    v_accvgpr_write_b32 a198, v94
    v_perm_b32 v95, v91, v90, s77
    v_accvgpr_write_b32 a199, v95
    s_add_u32 s64, s76, 3932160
    s_add_u32 m0, s71, 10240
    v_nop_e64
    buffer_load_dwordx4 v44, s[48:51], s64 offen lds
    s_add_u32 s64, s76, 4063232
    s_add_u32 m0, s71, 11264
    v_nop_e64
    buffer_load_dwordx4 v44, s[48:51], s64 offen lds
    s_add_u32 s64, s76, 4194304
    s_add_u32 m0, s71, 12288
    v_nop_e64
    buffer_load_dwordx4 v44, s[48:51], s64 offen lds
    s_add_u32 s64, s76, 4325376
    s_add_u32 m0, s71, 13312
    v_nop_e64
    buffer_load_dwordx4 v44, s[48:51], s64 offen lds
    s_add_u32 s64, s76, 4456448
    s_add_u32 m0, s71, 14336
    v_nop_e64
    buffer_load_dwordx4 v44, s[48:51], s64 offen lds
    s_add_u32 s64, s76, 4587520
    s_add_u32 m0, s71, 15360
    v_nop_e64
    buffer_load_dwordx4 v44, s[48:51], s64 offen lds
    s_add_u32 s64, s76, 4718592
    s_add_u32 m0, s71, 16384
    v_nop_e64
    buffer_load_dwordx4 v44, s[48:51], s64 offen lds
    s_add_u32 s64, s76, 4849664
    s_add_u32 m0, s71, 17408
    v_nop_e64
    buffer_load_dwordx4 v44, s[48:51], s64 offen lds
    s_add_u32 s64, s76, 4980736
    s_add_u32 m0, s71, 18432
    v_nop_e64
    buffer_load_dwordx4 v44, s[48:51], s64 offen lds
    s_add_u32 s64, s76, 5111808
    s_add_u32 m0, s71, 19456
    v_nop_e64
    buffer_load_dwordx4 v44, s[48:51], s64 offen lds
    s_waitcnt vmcnt(20)
    s_nop 0
    v_add_u32 v49, 20480, v48
    ds_read2_b32 v[52:53], v49 offset0:0 offset1:16
    ds_read2_b32 v[54:55], v49 offset0:32 offset1:48
    ds_read2_b32 v[56:57], v49 offset0:64 offset1:80
    ds_read2_b32 v[58:59], v49 offset0:96 offset1:112
    v_add_u32 v49, 22528, v48
    ds_read2_b32 v[60:61], v49 offset0:0 offset1:16
    ds_read2_b32 v[62:63], v49 offset0:32 offset1:48
    ds_read2_b32 v[64:65], v49 offset0:64 offset1:80
    ds_read2_b32 v[66:67], v49 offset0:96 offset1:112
    v_add_u32 v49, 24576, v48
    ds_read2_b32 v[68:69], v49 offset0:0 offset1:16
    ds_read2_b32 v[70:71], v49 offset0:32 offset1:48
    ds_read2_b32 v[72:73], v49 offset0:64 offset1:80
    ds_read2_b32 v[74:75], v49 offset0:96 offset1:112
    s_waitcnt lgkmcnt(6)
    s_nop 0
    v_add_u32 v49, 26624, v48
    ds_read2_b32 v[76:77], v49 offset0:0 offset1:16
    ds_read2_b32 v[78:79], v49 offset0:32 offset1:48
    ds_read2_b32 v[80:81], v49 offset0:64 offset1:80
    ds_read2_b32 v[82:83], v49 offset0:96 offset1:112
    v_add_u32 v49, 28672, v48
    ds_read2_b32 v[84:85], v49 offset0:0 offset1:16
    ds_read2_b32 v[86:87], v49 offset0:32 offset1:48
    ds_read2_b32 v[88:89], v49 offset0:64 offset1:80
    ds_read2_b32 v[90:91], v49 offset0:96 offset1:112
    s_waitcnt lgkmcnt(15)
    s_nop 0
    v_perm_b32 v92, v53, v52, s78
    v_accvgpr_write_b32 a200, v92
    v_perm_b32 v93, v55, v54, s78
    v_accvgpr_write_b32 a201, v93
    v_perm_b32 v94, v57, v56, s78
    v_accvgpr_write_b32 a202, v94
    v_perm_b32 v95, v59, v58, s78
    v_accvgpr_write_b32 a203, v95
    v_perm_b32 v92, v53, v52, s77
    v_accvgpr_write_b32 a204, v92
    v_perm_b32 v93, v55, v54, s77
    v_accvgpr_write_b32 a205, v93
    v_perm_b32 v94, v57, v56, s77
    v_accvgpr_write_b32 a206, v94
    v_perm_b32 v95, v59, v58, s77
    v_accvgpr_write_b32 a207, v95
    s_waitcnt lgkmcnt(12)
    s_nop 0
    v_perm_b32 v92, v61, v60, s78
    v_accvgpr_write_b32 a208, v92
    v_perm_b32 v93, v63, v62, s78
    v_accvgpr_write_b32 a209, v93
    v_perm_b32 v94, v65, v64, s78
    v_accvgpr_write_b32 a210, v94
    v_perm_b32 v95, v67, v66, s78
    v_accvgpr_write_b32 a211, v95
    v_perm_b32 v92, v61, v60, s77
    v_accvgpr_write_b32 a212, v92
    v_perm_b32 v93, v63, v62, s77
    v_accvgpr_write_b32 a213, v93
    v_perm_b32 v94, v65, v64, s77
    v_accvgpr_write_b32 a214, v94
    v_perm_b32 v95, v67, v66, s77
    v_accvgpr_write_b32 a215, v95
    s_waitcnt lgkmcnt(8)
    s_nop 0
    v_perm_b32 v92, v69, v68, s78
    v_accvgpr_write_b32 a216, v92
    v_perm_b32 v93, v71, v70, s78
    v_accvgpr_write_b32 a217, v93
    v_perm_b32 v94, v73, v72, s78
    v_accvgpr_write_b32 a218, v94
    v_perm_b32 v95, v75, v74, s78
    v_accvgpr_write_b32 a219, v95
    v_perm_b32 v92, v69, v68, s77
    v_accvgpr_write_b32 a220, v92
    v_perm_b32 v93, v71, v70, s77
    v_accvgpr_write_b32 a221, v93
    v_perm_b32 v94, v73, v72, s77
    v_accvgpr_write_b32 a222, v94
    v_perm_b32 v95, v75, v74, s77
    v_accvgpr_write_b32 a223, v95
    s_waitcnt lgkmcnt(4)
    s_nop 0
    v_perm_b32 v92, v77, v76, s78
    v_accvgpr_write_b32 a224, v92
    v_perm_b32 v93, v79, v78, s78
    v_accvgpr_write_b32 a225, v93
    v_perm_b32 v94, v81, v80, s78
    v_accvgpr_write_b32 a226, v94
    v_perm_b32 v95, v83, v82, s78
    v_accvgpr_write_b32 a227, v95
    v_perm_b32 v92, v77, v76, s77
    v_accvgpr_write_b32 a228, v92
    v_perm_b32 v93, v79, v78, s77
    v_accvgpr_write_b32 a229, v93
    v_perm_b32 v94, v81, v80, s77
    v_accvgpr_write_b32 a230, v94
    v_perm_b32 v95, v83, v82, s77
    v_accvgpr_write_b32 a231, v95
    s_waitcnt lgkmcnt(0)
    s_nop 0
    v_perm_b32 v92, v85, v84, s78
    v_accvgpr_write_b32 a232, v92
    v_perm_b32 v93, v87, v86, s78
    v_accvgpr_write_b32 a233, v93
    v_perm_b32 v94, v89, v88, s78
    v_accvgpr_write_b32 a234, v94
    v_perm_b32 v95, v91, v90, s78
    v_accvgpr_write_b32 a235, v95
    v_perm_b32 v92, v85, v84, s77
    v_accvgpr_write_b32 a236, v92
    v_perm_b32 v93, v87, v86, s77
    v_accvgpr_write_b32 a237, v93
    v_perm_b32 v94, v89, v88, s77
    v_accvgpr_write_b32 a238, v94
    v_perm_b32 v95, v91, v90, s77
    v_accvgpr_write_b32 a239, v95
    s_waitcnt vmcnt(10)
    v_add_u32 v49, 0, v48
    ds_read2_b32 v[52:53], v49 offset0:0 offset1:16
    ds_read2_b32 v[54:55], v49 offset0:32 offset1:48
    ds_read2_b32 v[56:57], v49 offset0:64 offset1:80
    ds_read2_b32 v[58:59], v49 offset0:96 offset1:112
    v_add_u32 v49, 2048, v48
    ds_read2_b32 v[60:61], v49 offset0:0 offset1:16
    ds_read2_b32 v[62:63], v49 offset0:32 offset1:48
    ds_read2_b32 v[64:65], v49 offset0:64 offset1:80
    ds_read2_b32 v[66:67], v49 offset0:96 offset1:112
    v_add_u32 v49, 4096, v48
    ds_read2_b32 v[68:69], v49 offset0:0 offset1:16
    ds_read2_b32 v[70:71], v49 offset0:32 offset1:48
    ds_read2_b32 v[72:73], v49 offset0:64 offset1:80
    ds_read2_b32 v[74:75], v49 offset0:96 offset1:112
    s_waitcnt lgkmcnt(6)
    s_nop 0
    v_add_u32 v49, 6144, v48
    ds_read2_b32 v[76:77], v49 offset0:0 offset1:16
    ds_read2_b32 v[78:79], v49 offset0:32 offset1:48
    ds_read2_b32 v[80:81], v49 offset0:64 offset1:80
    ds_read2_b32 v[82:83], v49 offset0:96 offset1:112
    v_add_u32 v49, 8192, v48
    ds_read2_b32 v[84:85], v49 offset0:0 offset1:16
    ds_read2_b32 v[86:87], v49 offset0:32 offset1:48
    ds_read2_b32 v[88:89], v49 offset0:64 offset1:80
    ds_read2_b32 v[90:91], v49 offset0:96 offset1:112
    s_waitcnt lgkmcnt(15)
    s_nop 0
    v_perm_b32 v92, v53, v52, s78
    v_accvgpr_write_b32 a240, v92
    v_perm_b32 v93, v55, v54, s78
    v_accvgpr_write_b32 a241, v93
    v_perm_b32 v94, v57, v56, s78
    v_accvgpr_write_b32 a242, v94
    v_perm_b32 v95, v59, v58, s78
    v_accvgpr_write_b32 a243, v95
    v_perm_b32 v92, v53, v52, s77
    v_accvgpr_write_b32 a244, v92
    v_perm_b32 v93, v55, v54, s77
    v_accvgpr_write_b32 a245, v93
    v_perm_b32 v94, v57, v56, s77
    v_accvgpr_write_b32 a246, v94
    v_perm_b32 v95, v59, v58, s77
    v_accvgpr_write_b32 a247, v95
    s_waitcnt lgkmcnt(12)
    s_nop 0
    v_perm_b32 v92, v61, v60, s78
    v_accvgpr_write_b32 a248, v92
    v_perm_b32 v93, v63, v62, s78
    v_accvgpr_write_b32 a249, v93
    v_perm_b32 v94, v65, v64, s78
    v_accvgpr_write_b32 a250, v94
    v_perm_b32 v95, v67, v66, s78
    v_accvgpr_write_b32 a251, v95
    v_perm_b32 v92, v61, v60, s77
    v_accvgpr_write_b32 a252, v92
    v_perm_b32 v93, v63, v62, s77
    v_accvgpr_write_b32 a253, v93
    v_perm_b32 v94, v65, v64, s77
    v_accvgpr_write_b32 a254, v94
    v_perm_b32 v95, v67, v66, s77
    v_accvgpr_write_b32 a255, v95
    s_waitcnt lgkmcnt(8)
    s_nop 0
    v_perm_b32 v192, v69, v68, s78
    v_perm_b32 v193, v71, v70, s78
    v_perm_b32 v194, v73, v72, s78
    v_perm_b32 v195, v75, v74, s78
    v_perm_b32 v196, v69, v68, s77
    v_perm_b32 v197, v71, v70, s77
    v_perm_b32 v198, v73, v72, s77
    v_perm_b32 v199, v75, v74, s77
    s_waitcnt lgkmcnt(4)
    s_nop 0
    v_perm_b32 v200, v77, v76, s78
    v_perm_b32 v201, v79, v78, s78
    v_perm_b32 v202, v81, v80, s78
    v_perm_b32 v203, v83, v82, s78
    v_perm_b32 v204, v77, v76, s77
    v_perm_b32 v205, v79, v78, s77
    v_perm_b32 v206, v81, v80, s77
    v_perm_b32 v207, v83, v82, s77
    s_waitcnt lgkmcnt(0)
    s_nop 0
    v_perm_b32 v208, v85, v84, s78
    v_perm_b32 v209, v87, v86, s78
    v_perm_b32 v210, v89, v88, s78
    v_perm_b32 v211, v91, v90, s78
    v_perm_b32 v212, v85, v84, s77
    v_perm_b32 v213, v87, v86, s77
    v_perm_b32 v214, v89, v88, s77
    v_perm_b32 v215, v91, v90, s77
    s_waitcnt vmcnt(0)
    s_nop 0
    v_add_u32 v49, 10240, v48
    ds_read2_b32 v[52:53], v49 offset0:0 offset1:16
    ds_read2_b32 v[54:55], v49 offset0:32 offset1:48
    ds_read2_b32 v[56:57], v49 offset0:64 offset1:80
    ds_read2_b32 v[58:59], v49 offset0:96 offset1:112
    v_add_u32 v49, 12288, v48
    ds_read2_b32 v[60:61], v49 offset0:0 offset1:16
    ds_read2_b32 v[62:63], v49 offset0:32 offset1:48
    ds_read2_b32 v[64:65], v49 offset0:64 offset1:80
    ds_read2_b32 v[66:67], v49 offset0:96 offset1:112
    v_add_u32 v49, 14336, v48
    ds_read2_b32 v[68:69], v49 offset0:0 offset1:16
    ds_read2_b32 v[70:71], v49 offset0:32 offset1:48
    ds_read2_b32 v[72:73], v49 offset0:64 offset1:80
    ds_read2_b32 v[74:75], v49 offset0:96 offset1:112
    s_waitcnt lgkmcnt(6)
    s_nop 0
    v_add_u32 v49, 16384, v48
    ds_read2_b32 v[76:77], v49 offset0:0 offset1:16
    ds_read2_b32 v[78:79], v49 offset0:32 offset1:48
    ds_read2_b32 v[80:81], v49 offset0:64 offset1:80
    ds_read2_b32 v[82:83], v49 offset0:96 offset1:112
    v_add_u32 v49, 18432, v48
    ds_read2_b32 v[84:85], v49 offset0:0 offset1:16
    ds_read2_b32 v[86:87], v49 offset0:32 offset1:48
    ds_read2_b32 v[88:89], v49 offset0:64 offset1:80
    ds_read2_b32 v[90:91], v49 offset0:96 offset1:112
    s_waitcnt lgkmcnt(15)
    s_nop 0
    v_perm_b32 v216, v53, v52, s78
    v_perm_b32 v217, v55, v54, s78
    v_perm_b32 v218, v57, v56, s78
    v_perm_b32 v219, v59, v58, s78
    v_perm_b32 v220, v53, v52, s77
    v_perm_b32 v221, v55, v54, s77
    v_perm_b32 v222, v57, v56, s77
    v_perm_b32 v223, v59, v58, s77
    s_waitcnt lgkmcnt(12)
    s_nop 0
    v_perm_b32 v224, v61, v60, s78
    v_perm_b32 v225, v63, v62, s78
    v_perm_b32 v226, v65, v64, s78
    v_perm_b32 v227, v67, v66, s78
    v_perm_b32 v228, v61, v60, s77
    v_perm_b32 v229, v63, v62, s77
    v_perm_b32 v230, v65, v64, s77
    v_perm_b32 v231, v67, v66, s77
    s_waitcnt lgkmcnt(8)
    s_nop 0
    v_perm_b32 v232, v69, v68, s78
    v_perm_b32 v233, v71, v70, s78
    v_perm_b32 v234, v73, v72, s78
    v_perm_b32 v235, v75, v74, s78
    v_perm_b32 v236, v69, v68, s77
    v_perm_b32 v237, v71, v70, s77
    v_perm_b32 v238, v73, v72, s77
    v_perm_b32 v239, v75, v74, s77
    s_waitcnt lgkmcnt(4)
    s_nop 0
    v_perm_b32 v240, v77, v76, s78
    v_perm_b32 v241, v79, v78, s78
    v_perm_b32 v242, v81, v80, s78
    v_perm_b32 v243, v83, v82, s78
    v_perm_b32 v244, v77, v76, s77
    v_perm_b32 v245, v79, v78, s77
    v_perm_b32 v246, v81, v80, s77
    v_perm_b32 v247, v83, v82, s77
    s_waitcnt lgkmcnt(0)
    s_nop 0
    v_perm_b32 v248, v85, v84, s78
    v_perm_b32 v249, v87, v86, s78
    v_perm_b32 v250, v89, v88, s78
    v_perm_b32 v251, v91, v90, s78
    v_perm_b32 v252, v85, v84, s77
    v_perm_b32 v253, v87, v86, s77
    v_perm_b32 v254, v89, v88, s77
    v_perm_b32 v255, v91, v90, s77
    s_waitcnt vmcnt(56)
    s_nop 0
    v_perm_b32 v52, v112, v108, s78
    v_perm_b32 v53, v120, v116, s78
    v_perm_b32 v54, v128, v124, s78
    v_perm_b32 v55, v136, v132, s78
    v_perm_b32 v56, v112, v108, s77
    v_perm_b32 v57, v120, v116, s77
    v_perm_b32 v58, v128, v124, s77
    v_perm_b32 v59, v136, v132, s77
    v_perm_b32 v60, v113, v109, s78
    v_perm_b32 v61, v121, v117, s78
    v_perm_b32 v62, v129, v125, s78
    v_perm_b32 v63, v137, v133, s78
    v_perm_b32 v64, v113, v109, s77
    v_perm_b32 v65, v121, v117, s77
    v_perm_b32 v66, v129, v125, s77
    v_perm_b32 v67, v137, v133, s77
    v_perm_b32 v68, v114, v110, s78
    v_perm_b32 v69, v122, v118, s78
    v_perm_b32 v70, v130, v126, s78
    v_perm_b32 v71, v138, v134, s78
    v_perm_b32 v72, v114, v110, s77
    v_perm_b32 v73, v122, v118, s77
    v_perm_b32 v74, v130, v126, s77
    v_perm_b32 v75, v138, v134, s77
    v_perm_b32 v76, v115, v111, s78
    v_perm_b32 v77, v123, v119, s78
    v_perm_b32 v78, v131, v127, s78
    v_perm_b32 v79, v139, v135, s78
    v_perm_b32 v80, v115, v111, s77
    v_perm_b32 v81, v123, v119, s77
    v_perm_b32 v82, v131, v127, s77
    v_perm_b32 v83, v139, v135, s77
    v_perm_b32 v84, v141, v140, s78
    v_perm_b32 v85, v143, v142, s78
    v_perm_b32 v86, v145, v144, s78
    v_perm_b32 v87, v147, v146, s78
    v_perm_b32 v88, v141, v140, s77
    v_perm_b32 v89, v143, v142, s77
    v_perm_b32 v90, v145, v144, s77
    v_perm_b32 v91, v147, v146, s77
    ds_write_b128 v16, v[52:55] offset:0
    ds_write_b128 v16, v[56:59] offset:2048
    ds_write_b128 v16, v[60:63] offset:4096
    ds_write_b128 v16, v[64:67] offset:6144
    ds_write_b128 v16, v[68:71] offset:8192
    ds_write_b128 v16, v[72:75] offset:10240
    ds_write_b128 v16, v[76:79] offset:12288
    ds_write_b128 v16, v[80:83] offset:14336
    ds_write_b128 v16, v[84:87] offset:16384
    ds_write_b128 v16, v[88:91] offset:18432
    s_waitcnt lgkmcnt(0)
    s_waitcnt vmcnt(40)
    v_perm_b32 v52, v152, v148, s78
    v_perm_b32 v53, v160, v156, s78
    v_perm_b32 v54, v168, v164, s78
    v_perm_b32 v55, v176, v172, s78
    v_perm_b32 v56, v152, v148, s77
    v_perm_b32 v57, v160, v156, s77
    v_perm_b32 v58, v168, v164, s77
    v_perm_b32 v59, v176, v172, s77
    v_perm_b32 v60, v153, v149, s78
    v_perm_b32 v61, v161, v157, s78
    v_perm_b32 v62, v169, v165, s78
    v_perm_b32 v63, v177, v173, s78
    v_perm_b32 v64, v153, v149, s77
    v_perm_b32 v65, v161, v157, s77
    v_perm_b32 v66, v169, v165, s77
    v_perm_b32 v67, v177, v173, s77
    v_perm_b32 v68, v154, v150, s78
    v_perm_b32 v69, v162, v158, s78
    v_perm_b32 v70, v170, v166, s78
    v_perm_b32 v71, v178, v174, s78
    v_perm_b32 v72, v154, v150, s77
    v_perm_b32 v73, v162, v158, s77
    v_perm_b32 v74, v170, v166, s77
    v_perm_b32 v75, v178, v174, s77
    v_perm_b32 v76, v155, v151, s78
    v_perm_b32 v77, v163, v159, s78
    v_perm_b32 v78, v171, v167, s78
    v_perm_b32 v79, v179, v175, s78
    v_perm_b32 v80, v155, v151, s77
    v_perm_b32 v81, v163, v159, s77
    v_perm_b32 v82, v171, v167, s77
    v_perm_b32 v83, v179, v175, s77
    v_perm_b32 v84, v181, v180, s78
    v_perm_b32 v85, v183, v182, s78
    v_perm_b32 v86, v185, v184, s78
    v_perm_b32 v87, v187, v186, s78
    v_perm_b32 v100, v181, v180, s77
    v_perm_b32 v101, v183, v182, s77
    v_perm_b32 v102, v185, v184, s77
    v_perm_b32 v103, v187, v186, s77
    ds_write_b128 v16, v[52:55] offset:1024
    ds_write_b128 v16, v[56:59] offset:3072
    ds_write_b128 v16, v[60:63] offset:5120
    ds_write_b128 v16, v[64:67] offset:7168
    ds_write_b128 v16, v[68:71] offset:9216
    ds_write_b128 v16, v[72:75] offset:11264
    ds_write_b128 v16, v[76:79] offset:13312
    ds_write_b128 v16, v[80:83] offset:15360
    ds_write_b128 v16, v[84:87] offset:17408
    s_waitcnt lgkmcnt(0)
    s_nop 0
    s_add_u32 s64, s42, 40960
    buffer_load_dwordx4 v[108:111], v40, s[56:59], s64 offen offset:0
    buffer_load_dword v140, v41, s[56:59], s64 offen offset:0
    buffer_load_dwordx4 v[112:115], v40, s[56:59], s64 offen offset:1280
    buffer_load_dword v141, v41, s[56:59], s64 offen offset:1280
    buffer_load_dwordx4 v[116:119], v40, s[56:59], s64 offen offset:2560
    buffer_load_dword v142, v41, s[56:59], s64 offen offset:2560
    buffer_load_dwordx4 v[120:123], v40, s[56:59], s64 offen offset:3840
    buffer_load_dword v143, v41, s[56:59], s64 offen offset:3840
    s_add_u32 s64, s42, 46080
    buffer_load_dwordx4 v[124:127], v40, s[56:59], s64 offen offset:0
    buffer_load_dword v144, v41, s[56:59], s64 offen offset:0
    buffer_load_dwordx4 v[128:131], v40, s[56:59], s64 offen offset:1280
    buffer_load_dword v145, v41, s[56:59], s64 offen offset:1280
    buffer_load_dwordx4 v[132:135], v40, s[56:59], s64 offen offset:2560
    buffer_load_dword v146, v41, s[56:59], s64 offen offset:2560
    buffer_load_dwordx4 v[136:139], v40, s[56:59], s64 offen offset:3840
    buffer_load_dword v147, v41, s[56:59], s64 offen offset:3840
    s_add_u32 s64, s42, 122880
    buffer_load_dwordx4 v[148:151], v40, s[56:59], s64 offen offset:0
    buffer_load_dword v180, v41, s[56:59], s64 offen offset:0
    buffer_load_dwordx4 v[152:155], v40, s[56:59], s64 offen offset:1280
    buffer_load_dword v181, v41, s[56:59], s64 offen offset:1280
    buffer_load_dwordx4 v[156:159], v40, s[56:59], s64 offen offset:2560
    buffer_load_dword v182, v41, s[56:59], s64 offen offset:2560
    buffer_load_dwordx4 v[160:163], v40, s[56:59], s64 offen offset:3840
    buffer_load_dword v183, v41, s[56:59], s64 offen offset:3840
    s_add_u32 s64, s42, 128000
    buffer_load_dwordx4 v[164:167], v40, s[56:59], s64 offen offset:0
    buffer_load_dword v184, v41, s[56:59], s64 offen offset:0
    buffer_load_dwordx4 v[168:171], v40, s[56:59], s64 offen offset:1280
    buffer_load_dword v185, v41, s[56:59], s64 offen offset:1280
    buffer_load_dwordx4 v[172:175], v40, s[56:59], s64 offen offset:2560
    buffer_load_dword v186, v41, s[56:59], s64 offen offset:2560
    buffer_load_dwordx4 v[176:179], v40, s[56:59], s64 offen offset:3840
    buffer_load_dword v187, v41, s[56:59], s64 offen offset:3840
    s_mov_b32 s13, 0
    s_mov_b32 s12, 5120
    s_mov_b32 s14, 1
    s_add_u32 s11, s69, 0
    s_call_b64 s[100:101], R_WQ
    s_mov_b32 s13, 1
    s_mov_b32 s12, 1280
    s_mov_b32 s14, 0
    s_add_u32 s11, s69, 741376
    s_call_b64 s[100:101], R_WQ
    s_mov_b32 s13, 1
    s_mov_b32 s12, 2560
    s_mov_b32 s14, 0
    s_add_u32 s11, s69, 1482752
    s_call_b64 s[100:101], R_WQ
    s_mov_b32 s13, 1
    s_mov_b32 s12, 3840
    s_mov_b32 s14, 0
    s_add_u32 s11, s69, 2224128
    s_call_b64 s[100:101], R_WQ
    s_waitcnt vmcnt(16)
    v_perm_b32 v52, v112, v108, s78
    v_perm_b32 v53, v120, v116, s78
    v_perm_b32 v54, v128, v124, s78
    v_perm_b32 v55, v136, v132, s78
    v_perm_b32 v56, v112, v108, s77
    v_perm_b32 v57, v120, v116, s77
    v_perm_b32 v58, v128, v124, s77
    v_perm_b32 v59, v136, v132, s77
    v_perm_b32 v60, v113, v109, s78
    v_perm_b32 v61, v121, v117, s78
    v_perm_b32 v62, v129, v125, s78
    v_perm_b32 v63, v137, v133, s78
    v_perm_b32 v64, v113, v109, s77
    v_perm_b32 v65, v121, v117, s77
    v_perm_b32 v66, v129, v125, s77
    v_perm_b32 v67, v137, v133, s77
    v_perm_b32 v68, v114, v110, s78
    v_perm_b32 v69, v122, v118, s78
    v_perm_b32 v70, v130, v126, s78
    v_perm_b32 v71, v138, v134, s78
    v_perm_b32 v72, v114, v110, s77
    v_perm_b32 v73, v122, v118, s77
    v_perm_b32 v74, v130, v126, s77
    v_perm_b32 v75, v138, v134, s77
    v_perm_b32 v76, v115, v111, s78
    v_perm_b32 v77, v123, v119, s78
    v_perm_b32 v78, v131, v127, s78
    v_perm_b32 v79, v139, v135, s78
    v_perm_b32 v80, v115, v111, s77
    v_perm_b32 v81, v123, v119, s77
    v_perm_b32 v82, v131, v127, s77
    v_perm_b32 v83, v139, v135, s77
    v_perm_b32 v84, v141, v140, s78
    v_perm_b32 v85, v143, v142, s78
    v_perm_b32 v86, v145, v144, s78
    v_perm_b32 v87, v147, v146, s78
    v_perm_b32 v88, v141, v140, s77
    v_perm_b32 v89, v143, v142, s77
    v_perm_b32 v90, v145, v144, s77
    v_perm_b32 v91, v147, v146, s77
    ds_write_b128 v16, v[52:55] offset:19456
    ds_write_b128 v16, v[56:59] offset:21504
    ds_write_b128 v16, v[60:63] offset:23552
    ds_write_b128 v16, v[64:67] offset:25600
    ds_write_b128 v16, v[68:71] offset:27648
    ds_write_b128 v16, v[72:75] offset:29696
    ds_write_b128 v16, v[76:79] offset:31744
    ds_write_b128 v16, v[80:83] offset:33792
    ds_write_b128 v16, v[84:87] offset:35840
    ds_write_b128 v16, v[88:91] offset:37888
    s_waitcnt lgkmcnt(0)
    s_waitcnt vmcnt(0)
    v_perm_b32 v52, v152, v148, s78
    v_perm_b32 v53, v160, v156, s78
    v_perm_b32 v54, v168, v164, s78
    v_perm_b32 v55, v176, v172, s78
    v_perm_b32 v56, v152, v148, s77
    v_perm_b32 v57, v160, v156, s77
    v_perm_b32 v58, v168, v164, s77
    v_perm_b32 v59, v176, v172, s77
    v_perm_b32 v60, v153, v149, s78
    v_perm_b32 v61, v161, v157, s78
    v_perm_b32 v62, v169, v165, s78
    v_perm_b32 v63, v177, v173, s78
    v_perm_b32 v64, v153, v149, s77
    v_perm_b32 v65, v161, v157, s77
    v_perm_b32 v66, v169, v165, s77
    v_perm_b32 v67, v177, v173, s77
    v_perm_b32 v68, v154, v150, s78
    v_perm_b32 v69, v162, v158, s78
    v_perm_b32 v70, v170, v166, s78
    v_perm_b32 v71, v178, v174, s78
    v_perm_b32 v72, v154, v150, s77
    v_perm_b32 v73, v162, v158, s77
    v_perm_b32 v74, v170, v166, s77
    v_perm_b32 v75, v178, v174, s77
    v_perm_b32 v76, v155, v151, s78
    v_perm_b32 v77, v163, v159, s78
    v_perm_b32 v78, v171, v167, s78
    v_perm_b32 v79, v179, v175, s78
    v_perm_b32 v80, v155, v151, s77
    v_perm_b32 v81, v163, v159, s77
    v_perm_b32 v82, v171, v167, s77
    v_perm_b32 v83, v179, v175, s77
    v_perm_b32 v84, v181, v180, s78
    v_perm_b32 v85, v183, v182, s78
    v_perm_b32 v86, v185, v184, s78
    v_perm_b32 v87, v187, v186, s78
    v_perm_b32 v104, v181, v180, s77
    v_perm_b32 v105, v183, v182, s77
    v_perm_b32 v106, v185, v184, s77
    v_perm_b32 v107, v187, v186, s77
    ds_write_b128 v16, v[52:55] offset:20480
    ds_write_b128 v16, v[56:59] offset:22528
    ds_write_b128 v16, v[60:63] offset:24576
    ds_write_b128 v16, v[64:67] offset:26624
    ds_write_b128 v16, v[68:71] offset:28672
    ds_write_b128 v16, v[72:75] offset:30720
    ds_write_b128 v16, v[76:79] offset:32768
    ds_write_b128 v16, v[80:83] offset:34816
    ds_write_b128 v16, v[84:87] offset:36864
    s_waitcnt lgkmcnt(0)
    s_barrier
    v_and_b32 v44, 56, v1
    v_lshlrev_b32_e64 v44, 2, v44
L_AFW:
    buffer_load_dword v42, v44, s[84:87], 0 offen offset:4 sc1
    s_waitcnt vmcnt(0)
    v_and_b32 v43, 0xffff, v42
    v_cmp_gt_u32 vcc, 32, v43
    s_cbranch_vccz L_AFD
    s_cmp_eq_u32 s62, 0
    s_cbranch_scc1 L_AFD
    s_sub_u32 s62, s62, 1
    s_sleep 2
    s_branch L_AFW
L_AFD:
    v_cmp_eq_u32 vcc, 32, v42
    s_lshr_b32 s65, s3, 2
    s_nop 3
    s_lshr_b32 s65, vcc_lo, s65
    s_and_b32 s79, s65, 1
    s_mov_b32 s9, 0
    s_mov_b32 s14, 0
    s_mov_b32 s15, 2
    s_mov_b32 s18, 0x86534210
    s_mov_b32 s19, 0xfedbca97
    s_mov_b32 s90, 0x500000
L_CH:
    s_lshl_b32 s64, s9, 2
    s_lshr_b64 s[16:17], s[18:19], s64
    s_and_b32 s6, s16, 15
    s_and_b32 s13, s6, 1
    s_cmp_eq_u32 s13, s15
    s_cbranch_scc1 L_GOK
    s_cmp_eq_u32 s15, 3
    s_cbranch_scc1 L_GIS
    s_cmp_eq_u32 s13, 0
    s_cselect_b32 s88, s52, s56
    s_cselect_b32 s89, s53, s57
    v_mad_u32_u24 v40, v10, s74, v4
    v_and_b32_e64 v41, 63, v11
    v_add_u32 v41, 256, v41
    v_mad_u32_u24 v41, v10, s70, v41
    s_add_u32 s64, s42, 81920
    buffer_load_dwordx4 v[108:111], v40, s[88:91], s64 offen offset:0
    buffer_load_dword v140, v41, s[88:91], s64 offen offset:0
    buffer_load_dwordx4 v[112:115], v40, s[88:91], s64 offen offset:1280
    buffer_load_dword v141, v41, s[88:91], s64 offen offset:1280
    buffer_load_dwordx4 v[116:119], v40, s[88:91], s64 offen offset:2560
    buffer_load_dword v142, v41, s[88:91], s64 offen offset:2560
    buffer_load_dwordx4 v[120:123], v40, s[88:91], s64 offen offset:3840
    buffer_load_dword v143, v41, s[88:91], s64 offen offset:3840
    s_add_u32 s64, s42, 87040
    buffer_load_dwordx4 v[124:127], v40, s[88:91], s64 offen offset:0
    buffer_load_dword v144, v41, s[88:91], s64 offen offset:0
    buffer_load_dwordx4 v[128:131], v40, s[88:91], s64 offen offset:1280
    buffer_load_dword v145, v41, s[88:91], s64 offen offset:1280
    buffer_load_dwordx4 v[132:135], v40, s[88:91], s64 offen offset:2560
    buffer_load_dword v146, v41, s[88:91], s64 offen offset:2560
    buffer_load_dwordx4 v[136:139], v40, s[88:91], s64 offen offset:3840
    buffer_load_dword v147, v41, s[88:91], s64 offen offset:3840
    s_add_u32 s64, s42, 0
    s_nop 0
    buffer_load_dwordx4 v[148:151], v40, s[88:91], s64 offen offset:0
    buffer_load_dword v180, v41, s[88:91], s64 offen offset:0
    buffer_load_dwordx4 v[152:155], v40, s[88:91], s64 offen offset:1280
    buffer_load_dword v181, v41, s[88:91], s64 offen offset:1280
    buffer_load_dwordx4 v[156:159], v40, s[88:91], s64 offen offset:2560
    buffer_load_dword v182, v41, s[88:91], s64 offen offset:2560
    buffer_load_dwordx4 v[160:163], v40, s[88:91], s64 offen offset:3840
    buffer_load_dword v183, v41, s[88:91], s64 offen offset:3840
    s_add_u32 s64, s42, 5120
    buffer_load_dwordx4 v[164:167], v40, s[88:91], s64 offen offset:0
    buffer_load_dword v184, v41, s[88:91], s64 offen offset:0
    buffer_load_dwordx4 v[168:171], v40, s[88:91], s64 offen offset:1280
    buffer_load_dword v185, v41, s[88:91], s64 offen offset:1280
    buffer_load_dwordx4 v[172:175], v40, s[88:91], s64 offen offset:2560
    buffer_load_dword v186, v41, s[88:91], s64 offen offset:2560
    buffer_load_dwordx4 v[176:179], v40, s[88:91], s64 offen offset:3840
    buffer_load_dword v187, v41, s[88:91], s64 offen offset:3840
L_GIS:
    s_mov_b32 s15, s13
    s_cmp_eq_u32 s13, 0
    s_cselect_b64 vcc, -1, 0
    v_cndmask_b32 v188, v104, v100, vcc
    v_cndmask_b32 v189, v105, v101, vcc
    v_cndmask_b32 v190, v106, v102, vcc
    v_cndmask_b32 v191, v107, v103, vcc
    s_waitcnt vmcnt(16)
    v_perm_b32 v52, v112, v108, s78
    v_perm_b32 v53, v120, v116, s78
    v_perm_b32 v54, v128, v124, s78
    v_perm_b32 v55, v136, v132, s78
    v_perm_b32 v56, v112, v108, s77
    v_perm_b32 v57, v120, v116, s77
    v_perm_b32 v58, v128, v124, s77
    v_perm_b32 v59, v136, v132, s77
    v_perm_b32 v60, v113, v109, s78
    v_perm_b32 v61, v121, v117, s78
    v_perm_b32 v62, v129, v125, s78
    v_perm_b32 v63, v137, v133, s78
    v_perm_b32 v64, v113, v109, s77
    v_perm_b32 v65, v121, v117, s77
    v_perm_b32 v66, v129, v125, s77
    v_perm_b32 v67, v137, v133, s77
    v_perm_b32 v68, v114, v110, s78
    v_perm_b32 v69, v122, v118, s78
    v_perm_b32 v70, v130, v126, s78
    v_perm_b32 v71, v138, v134, s78
    v_perm_b32 v72, v114, v110, s77
    v_perm_b32 v73, v122, v118, s77
    v_perm_b32 v74, v130, v126, s77
    v_perm_b32 v75, v138, v134, s77
    v_perm_b32 v76, v115, v111, s78
    v_perm_b32 v77, v123, v119, s78
    v_perm_b32 v78, v131, v127, s78
    v_perm_b32 v79, v139, v135, s78
    v_perm_b32 v80, v115, v111, s77
    v_perm_b32 v81, v123, v119, s77
    v_perm_b32 v82, v131, v127, s77
    v_perm_b32 v83, v139, v135, s77
    v_perm_b32 v84, v141, v140, s78
    v_perm_b32 v85, v143, v142, s78
    v_perm_b32 v86, v145, v144, s78
    v_perm_b32 v87, v147, v146, s78
    v_perm_b32 v88, v141, v140, s77
    v_perm_b32 v89, v143, v142, s77
    v_perm_b32 v90, v145, v144, s77
    v_perm_b32 v91, v147, v146, s77
    s_waitcnt vmcnt(0)
    s_nop 0
    v_perm_b32 v108, v152, v148, s78
    v_perm_b32 v109, v160, v156, s78
    v_perm_b32 v110, v168, v164, s78
    v_perm_b32 v111, v176, v172, s78
    v_perm_b32 v112, v152, v148, s77
    v_perm_b32 v113, v160, v156, s77
    v_perm_b32 v114, v168, v164, s77
    v_perm_b32 v115, v176, v172, s77
    v_perm_b32 v116, v153, v149, s78
    v_perm_b32 v117, v161, v157, s78
    v_perm_b32 v118, v169, v165, s78
    v_perm_b32 v119, v177, v173, s78
    v_perm_b32 v120, v153, v149, s77
    v_perm_b32 v121, v161, v157, s77
    v_perm_b32 v122, v169, v165, s77
    v_perm_b32 v123, v177, v173, s77
    v_perm_b32 v124, v154, v150, s78
    v_perm_b32 v125, v162, v158, s78
    v_perm_b32 v126, v170, v166, s78
    v_perm_b32 v127, v178, v174, s78
    v_perm_b32 v128, v154, v150, s77
    v_perm_b32 v129, v162, v158, s77
    v_perm_b32 v130, v170, v166, s77
    v_perm_b32 v131, v178, v174, s77
    v_perm_b32 v132, v155, v151, s78
    v_perm_b32 v133, v163, v159, s78
    v_perm_b32 v134, v171, v167, s78
    v_perm_b32 v135, v179, v175, s78
    v_perm_b32 v136, v155, v151, s77
    v_perm_b32 v137, v163, v159, s77
    v_perm_b32 v138, v171, v167, s77
    v_perm_b32 v139, v179, v175, s77
    v_perm_b32 v140, v181, v180, s78
    v_perm_b32 v141, v183, v182, s78
    v_perm_b32 v142, v185, v184, s78
    v_perm_b32 v143, v187, v186, s78
    v_perm_b32 v144, v181, v180, s77
    v_perm_b32 v145, v183, v182, s77
    v_perm_b32 v146, v185, v184, s77
    v_perm_b32 v147, v187, v186, s77
    v_mov_b64 v[148:149], v[52:53]
    v_mov_b64 v[150:151], v[54:55]
    v_mov_b64 v[152:153], v[56:57]
    v_mov_b64 v[154:155], v[58:59]
    v_mov_b64 v[156:157], v[60:61]
    v_mov_b64 v[158:159], v[62:63]
    v_mov_b64 v[160:161], v[64:65]
    v_mov_b64 v[162:163], v[66:67]
    v_mov_b64 v[164:165], v[68:69]
    v_mov_b64 v[166:167], v[70:71]
    v_mov_b64 v[168:169], v[72:73]
    v_mov_b64 v[170:171], v[74:75]
    v_mov_b64 v[172:173], v[76:77]
    v_mov_b64 v[174:175], v[78:79]
    v_mov_b64 v[176:177], v[80:81]
    v_mov_b64 v[178:179], v[82:83]
    v_mov_b64 v[180:181], v[84:85]
    v_mov_b64 v[182:183], v[86:87]
    v_mov_b64 v[184:185], v[88:89]
    v_mov_b64 v[186:187], v[90:91]
L_GOK:
    s_mul_i32 s64, s6, 185344
    s_add_u32 s7, s64, s43
    s_add_u32 s8, s64, s68
    s_add_u32 s10, s64, s75
    s_add_u32 s11, s64, s69
    s_add_u32 s11, s11, 185344
    s_lshr_b32 s12, s6, 2
    s_mul_i32 s12, s12, 1280
    s_mul_i32 s64, s13, 19456
    v_add_u32 v44, s64, v16
    v_add_u32 v45, s12, v8
    v_add_u32 v46, s12, v9
    ds_read_u16 v47, v45
    ds_read_u16 v48, v45 offset:8
    ds_read_u16 v49, v46
    ds_read_b128 v[84:87], v44 offset:0
    ds_read_b128 v[88:91], v44 offset:1024
    ds_read_b128 v[92:95], v44 offset:2048
    ds_read_b128 v[96:99], v44 offset:3072
    s_waitcnt lgkmcnt(0)
    v_lshlrev_b32 v47, 16, v47
    v_lshlrev_b32 v48, 16, v48
    v_lshlrev_b32 v49, 16, v49
HA_L:
    buffer_load_dwordx2 v[34:35], v2, s[80:83], s7 offen sc1
    buffer_load_dwordx2 v[20:21], v1, s[80:83], s7 offen offset:0 sc1
    buffer_load_dwordx2 v[22:23], v1, s[80:83], s7 offen offset:512 sc1
    buffer_load_dwordx2 v[24:25], v1, s[80:83], s7 offen offset:1024 sc1
    buffer_load_dwordx2 v[26:27], v1, s[80:83], s7 offen offset:1536 sc1
    buffer_load_dwordx2 v[28:29], v1, s[80:83], s7 offen offset:2048 sc1
    buffer_load_dwordx2 v[30:31], v1, s[80:83], s7 offen offset:2560 sc1
    buffer_load_dwordx2 v[32:33], v1, s[80:83], s7 offen offset:3072 sc1
    s_waitcnt vmcnt(7)
    v_max_f32_dpp v36, v34, v34 quad_perm:[1,0,3,2] row_mask:0xf bank_mask:0xf
    v_mul_f32 v37, v35, v3
    v_nop_e64
    v_max_f32_dpp v36, v36, v36 quad_perm:[2,3,0,1] row_mask:0xf bank_mask:0xf
    s_nop 0
    s_nop 0
    v_max_f32_dpp v36, v36, v36 row_half_mirror row_mask:0xf bank_mask:0xf
    v_sub_f32 v38, v34, v36
    v_exp_f32 v38, v38
    v_nop_e64
    v_mul_f32 v37, v37, v38
    s_waitcnt vmcnt(0)
    v_mul_f32_dpp v40, v38, v20 row_newbcast:0 row_mask:0xf bank_mask:0xf
    v_mul_f32_dpp v41, v38, v21 row_newbcast:0 row_mask:0xf bank_mask:0xf
    v_add_f32_dpp v37, v37, v37 quad_perm:[1,0,3,2] row_mask:0xf bank_mask:0xf
    v_mul_f32_dpp v42, v38, v22 row_newbcast:1 row_mask:0xf bank_mask:0xf
    v_mul_f32_dpp v43, v38, v23 row_newbcast:1 row_mask:0xf bank_mask:0xf
    v_fmac_f32_dpp v40, v38, v24 row_newbcast:2 row_mask:0xf bank_mask:0xf
    v_fmac_f32_dpp v41, v38, v25 row_newbcast:2 row_mask:0xf bank_mask:0xf
    v_add_f32_dpp v37, v37, v37 quad_perm:[2,3,0,1] row_mask:0xf bank_mask:0xf
    v_fmac_f32_dpp v42, v38, v26 row_newbcast:3 row_mask:0xf bank_mask:0xf
    v_fmac_f32_dpp v43, v38, v27 row_newbcast:3 row_mask:0xf bank_mask:0xf
    v_fmac_f32_dpp v40, v38, v28 row_newbcast:4 row_mask:0xf bank_mask:0xf
    v_fmac_f32_dpp v41, v38, v29 row_newbcast:4 row_mask:0xf bank_mask:0xf
    v_add_f32_dpp v37, v37, v37 row_half_mirror row_mask:0xf bank_mask:0xf
    v_fmac_f32_dpp v42, v38, v30 row_newbcast:5 row_mask:0xf bank_mask:0xf
    v_fmac_f32_dpp v43, v38, v31 row_newbcast:5 row_mask:0xf bank_mask:0xf
    v_rcp_f32_e64 v37, v37
    v_fmac_f32_dpp v40, v38, v32 row_newbcast:6 row_mask:0xf bank_mask:0xf
    v_fmac_f32_dpp v41, v38, v33 row_newbcast:6 row_mask:0xf bank_mask:0xf
    v_pk_add_f32 v[40:41], v[40:41], v[42:43]
    v_mul_f32 v40, v40, v37
    v_mul_f32 v41, v41, v37
    v_cmp_u_f32_e64 vcc, v40, v41
    v_cvt_pk_bf16_f32 v40, v40, v41
    s_cbranch_vccz HA_P
    s_nop 0
    v_max3_u32 v39, v20, v21, v22
    v_max3_u32 v39, v39, v23, v24
    v_max3_u32 v39, v39, v25, v26
    v_max3_u32 v39, v39, v27, v28
    v_max3_u32 v39, v39, v29, v30
    v_max3_u32 v39, v39, v31, v32
    v_max3_u32 v39, v39, v33, v34
    v_max3_u32 v39, v39, v35, v35
    v_cmp_eq_u32 vcc, -1, v39
    s_cbranch_vccz HA_P
    s_cmp_eq_u32 s62, 0
    s_cbranch_scc1 HA_P
    s_sub_u32 s62, s62, 1
    s_branch HA_L
HA_P:
    ds_write_b32 v6, v40
    ds_read_b128 v[52:55], v7 offset:0
    ds_read_b128 v[56:59], v7 offset:64
    ds_read_b128 v[60:63], v7 offset:128
    ds_read_b128 v[64:67], v7 offset:192
    ds_read_b128 v[20:23], v44 offset:4096
    ds_read_b128 v[24:27], v44 offset:5120
    ds_read_b128 v[28:31], v44 offset:6144
    ds_read_b128 v[32:35], v44 offset:7168
    s_waitcnt lgkmcnt(7)
    v_mfma_f32_16x16x32_bf16 v[68:71], v[52:55], v[108:111], 0
    s_waitcnt lgkmcnt(6)
    v_mfma_f32_16x16x32_bf16 v[68:71], v[56:59], v[84:87], v[68:71]
    ds_read_b128 v[84:87], v44 offset:8192
    s_waitcnt lgkmcnt(6)
    v_mfma_f32_16x16x32_bf16 v[68:71], v[60:63], v[148:151], v[68:71]
    s_waitcnt lgkmcnt(5)
    v_mfma_f32_16x16x32_bf16 v[68:71], v[64:67], v[88:91], v[68:71]
    ds_read_b128 v[88:91], v44 offset:9216
    v_mfma_f32_16x16x32_bf16 v[72:75], v[52:55], v[112:115], 0
    v_mfma_f32_16x16x32_bf16 v[72:75], v[56:59], v[92:95], v[72:75]
    ds_read_b128 v[92:95], v44 offset:10240
    v_mfma_f32_16x16x32_bf16 v[72:75], v[60:63], v[152:155], v[72:75]
    v_mfma_f32_16x16x32_bf16 v[72:75], v[64:67], v[96:99], v[72:75]
    ds_read_b128 v[96:99], v44 offset:11264
    v_mfma_f32_16x16x32_bf16 v[76:79], v[52:55], v[116:119], 0
    s_waitcnt lgkmcnt(7)
    v_mfma_f32_16x16x32_bf16 v[76:79], v[56:59], v[20:23], v[76:79]
    ds_read_b128 v[20:23], v44 offset:12288
    v_mfma_f32_16x16x32_bf16 v[76:79], v[60:63], v[156:159], v[76:79]
    s_waitcnt lgkmcnt(7)
    v_mfma_f32_16x16x32_bf16 v[76:79], v[64:67], v[24:27], v[76:79]
    ds_read_b128 v[24:27], v44 offset:13312
    v_mfma_f32_16x16x32_bf16 v[80:83], v[52:55], v[120:123], 0
    s_waitcnt lgkmcnt(7)
    v_mfma_f32_16x16x32_bf16 v[80:83], v[56:59], v[28:31], v[80:83]
    ds_read_b128 v[28:31], v44 offset:14336
    s_mov_b64 exec, 0xffff
    ds_write2_b32 v18, v68, v72 offset0:0 offset1:1
    s_mov_b64 exec, -1
    v_mfma_f32_16x16x32_bf16 v[80:83], v[60:63], v[160:163], v[80:83]
    s_waitcnt lgkmcnt(8)
    v_mfma_f32_16x16x32_bf16 v[80:83], v[64:67], v[32:35], v[80:83]
    ds_read_b128 v[32:35], v44 offset:15360
    v_mfma_f32_16x16x32_bf16 v[68:71], v[52:55], v[124:127], 0
    s_waitcnt lgkmcnt(8)
    v_mfma_f32_16x16x32_bf16 v[68:71], v[56:59], v[84:87], v[68:71]
    ds_read_b128 v[84:87], v44 offset:16384
    v_mfma_f32_16x16x32_bf16 v[68:71], v[60:63], v[164:167], v[68:71]
    s_waitcnt lgkmcnt(8)
    v_mfma_f32_16x16x32_bf16 v[68:71], v[64:67], v[88:91], v[68:71]
    ds_read_b128 v[88:91], v44 offset:17408
    v_mfma_f32_16x16x32_bf16 v[72:75], v[52:55], v[128:131], 0
    s_waitcnt lgkmcnt(8)
    v_mfma_f32_16x16x32_bf16 v[72:75], v[56:59], v[92:95], v[72:75]
    ds_read_b128 v[92:95], v44 offset:18432
    s_mov_b64 exec, 0xffff
    ds_write2_b32 v18, v76, v80 offset0:2 offset1:3
    s_mov_b64 exec, -1
    v_mfma_f32_16x16x32_bf16 v[72:75], v[60:63], v[168:171], v[72:75]
    s_waitcnt lgkmcnt(9)
    v_mfma_f32_16x16x32_bf16 v[72:75], v[64:67], v[96:99], v[72:75]
    v_mfma_f32_16x16x32_bf16 v[76:79], v[52:55], v[132:135], 0
    s_waitcnt lgkmcnt(8)
    v_mfma_f32_16x16x32_bf16 v[76:79], v[56:59], v[20:23], v[76:79]
    v_mfma_f32_16x16x32_bf16 v[76:79], v[60:63], v[172:175], v[76:79]
    s_waitcnt lgkmcnt(7)
    v_mfma_f32_16x16x32_bf16 v[76:79], v[64:67], v[24:27], v[76:79]
    v_mfma_f32_16x16x32_bf16 v[80:83], v[52:55], v[136:139], 0
    s_waitcnt lgkmcnt(6)
    v_mfma_f32_16x16x32_bf16 v[80:83], v[56:59], v[28:31], v[80:83]
    s_mov_b64 exec, 0xffff
    ds_write2_b32 v18, v68, v72 offset0:64 offset1:65
    s_mov_b64 exec, -1
    v_mfma_f32_16x16x32_bf16 v[80:83], v[60:63], v[176:179], v[80:83]
    s_waitcnt lgkmcnt(5)
    v_mfma_f32_16x16x32_bf16 v[80:83], v[64:67], v[32:35], v[80:83]
    v_mfma_f32_16x16x32_bf16 v[68:71], v[52:55], v[140:143], 0
    s_waitcnt lgkmcnt(4)
    v_mfma_f32_16x16x32_bf16 v[68:71], v[56:59], v[84:87], v[68:71]
    v_mfma_f32_16x16x32_bf16 v[68:71], v[60:63], v[180:183], v[68:71]
    s_waitcnt lgkmcnt(3)
    v_mfma_f32_16x16x32_bf16 v[68:71], v[64:67], v[88:91], v[68:71]
    v_mfma_f32_16x16x32_bf16 v[72:75], v[52:55], v[144:147], 0
    s_waitcnt lgkmcnt(2)
    v_mfma_f32_16x16x32_bf16 v[72:75], v[56:59], v[92:95], v[72:75]
    s_mov_b64 exec, 0xffff
    ds_write2_b32 v18, v76, v80 offset0:66 offset1:67
    s_mov_b64 exec, -1
    v_mfma_f32_16x16x32_bf16 v[72:75], v[60:63], v[184:187], v[72:75]
    v_mfma_f32_16x16x32_bf16 v[72:75], v[64:67], v[188:191], v[72:75]
    s_mov_b64 exec, 0xffff
    s_nop 5
    s_nop 0
    ds_write2_b32 v19, v68, v72 offset0:128 offset1:129
    s_mov_b64 exec, -1
    s_waitcnt lgkmcnt(0)
    s_barrier
    s_cmp_lg_u32 s5, 0
    s_cbranch_scc1 HB_W
    s_mov_b32 exec_hi, 0xff
    ds_read_b128 v[20:23], v18 offset:0
    ds_read_b128 v[24:27], v18 offset:640
    ds_read_b128 v[28:31], v18 offset:1280
    ds_read_b128 v[32:35], v18 offset:1920
    s_waitcnt lgkmcnt(2)
    v_pk_add_f32 v[20:21], v[20:21], v[24:25]
    v_pk_add_f32 v[22:23], v[22:23], v[26:27]
    s_waitcnt lgkmcnt(0)
    v_pk_add_f32 v[28:29], v[28:29], v[32:33]
    v_pk_add_f32 v[30:31], v[30:31], v[34:35]
    v_pk_add_f32 v[20:21], v[20:21], v[28:29]
    v_pk_add_f32 v[22:23], v[22:23], v[30:31]
    v_min_u32 v20, -2, v20
    v_min_u32 v21, -2, v21
    v_min_u32 v22, -2, v22
    v_min_u32_e64 v23, -2, v23
    buffer_store_dwordx4 v[20:23], v17, s[80:83], s10 offen sc1
    s_mov_b64 exec, -1
    s_branch HB_0
HB_W:
    s_sleep 4
HB_0:
    s_and_b32 s64, s6, 3
    s_cmp_eq_u32 s64, 3
    s_cbranch_scc1 L_FINAL
HB_L:
    s_sleep 10
    buffer_load_dwordx4 v[62:65], v4, s[80:83], s8 offen offset:0 sc1
    buffer_load_dwordx4 v[66:69], v4, s[80:83], s8 offen offset:256 sc1
    buffer_load_dwordx2 v[70:71], v5, s[80:83], s8 offen offset:0 sc1
    buffer_load_dwordx4 v[72:75], v4, s[80:83], s8 offen offset:640 sc1
    buffer_load_dwordx4 v[76:79], v4, s[80:83], s8 offen offset:896 sc1
    buffer_load_dwordx2 v[80:81], v5, s[80:83], s8 offen offset:640 sc1
HB_R:
    s_waitcnt vmcnt(0)
    s_nop 0
    v_pk_add_f32 v[52:53], v[62:63], v[72:73]
    v_pk_add_f32 v[54:55], v[64:65], v[74:75]
    v_pk_add_f32 v[56:57], v[66:67], v[76:77]
    v_pk_add_f32 v[58:59], v[68:69], v[78:79]
    v_pk_add_f32 v[60:61], v[70:71], v[80:81]
    v_permlane32_swap_b32 v52, v53
    v_permlane32_swap_b32 v54, v55
    v_permlane32_swap_b32 v56, v57
    v_permlane32_swap_b32 v58, v59
    v_permlane32_swap_b32 v60, v61
    v_add_f32 v60, v60, v61
    v_mov_b32 v61, v60
    v_add_f32 v52, v52, v53
    v_add_f32 v54, v54, v55
    v_add_f32 v56, v56, v57
    v_add_f32 v58, v58, v59
    v_permlane16_swap_b32 v60, v61
    v_permlane16_swap_b32 v52, v54
    v_permlane16_swap_b32 v56, v58
    v_add_f32 v60, v60, v61
    v_add_f32 v52, v52, v54
    v_add_f32 v56, v56, v58
    v_add_f32 v61, v60, v52
    v_cmp_u_f32 vcc, v61, v56
    s_cbranch_vccz HB_P
    v_max3_u32 v39, v62, v63, v64
    v_max3_u32 v39, v39, v65, v66
    v_max3_u32 v39, v39, v67, v68
    v_max3_u32 v39, v39, v69, v70
    v_max3_u32 v39, v39, v71, v72
    v_max3_u32 v39, v39, v73, v74
    v_max3_u32 v39, v39, v75, v76
    v_max3_u32 v39, v39, v77, v78
    v_max3_u32 v39, v39, v79, v80
    v_max3_u32 v39, v39, v81, v81
    v_cmp_eq_u32_e64 vcc, -1, v39
    s_cbranch_vccz HB_P
    s_cmp_eq_u32 s62, 0
    s_cbranch_scc1 HB_P
    s_sub_u32 s62, s62, 1
    buffer_load_dwordx4 v[62:65], v4, s[80:83], s8 offen offset:0 sc1
    buffer_load_dwordx4 v[66:69], v4, s[80:83], s8 offen offset:256 sc1
    buffer_load_dwordx2 v[70:71], v5, s[80:83], s8 offen offset:0 sc1
    buffer_load_dwordx4 v[72:75], v4, s[80:83], s8 offen offset:640 sc1
    buffer_load_dwordx4 v[76:79], v4, s[80:83], s8 offen offset:896 sc1
    buffer_load_dwordx2 v[80:81], v5, s[80:83], s8 offen offset:640 sc1
    s_branch HB_R
HB_P:
    v_cvt_pk_bf16_f32 v60, v60, v60
    v_cvt_pk_bf16_f32 v52, v52, v56
    v_lshlrev_b32 v60, 16, v60
    v_lshlrev_b32_e64 v53, 16, v52
    v_and_b32 v54, 0xffff0000, v52
    v_add_f32 v60, v60, v49
    v_add_f32 v53, v53, v47
    v_add_f32_e64 v54, v54, v48
    v_cvt_pk_bf16_f32 v41, v60, v60
    v_cvt_pk_bf16_f32 v40, v53, v54
    s_cmp_eq_u32 s9, 16
    s_cbranch_scc1 L_OUT
    ds_write_b16 v46, v41
    ds_write_b16 v45, v40
    ds_write_b16_d16_hi v45, v40 offset:8
    v_add_u32 v50, s12, v10
    v_add_u32 v51, s12, v11
    v_mov_b32 v36, 0
    v_mov_b32 v37, 0
    v_mov_b32 v38, 0x3f803f80
    s_waitcnt lgkmcnt(0)
    s_barrier
    s_call_b64 s[100:101], R_WQ2
    s_mov_b32 s14, 0
    s_add_u32 s9, s9, 1
    s_branch L_CH
L_FINAL:
    s_barrier
    s_add_u32 s9, s9, 1
    s_cmp_lt_u32 s9, 16
    s_cbranch_scc1 L_CH
    s_cmp_gt_u32 s3, 3
    s_cbranch_scc1 L_FIN
    s_cmp_eq_u32 s3, 3
    s_cbranch_scc1 HB_L
    s_lshl_b32 s64, s3, 2
    s_add_u32 s64, s64, 3
    s_mul_i32 s64, s64, 185344
    s_add_u32 s8, s64, s68
    s_mul_i32 s12, s3, 1280
    v_add_u32 v45, s12, v8
    v_add_u32_e64 v46, s12, v9
    ds_read_u16 v47, v45
    ds_read_u16 v48, v45 offset:8
    ds_read_u16 v49, v46
    s_waitcnt lgkmcnt(0)
    v_lshlrev_b32 v47, 16, v47
    v_lshlrev_b32 v48, 16, v48
    v_lshlrev_b32 v49, 16, v49
    s_nop 0
    s_branch HB_L
L_OUT:
    buffer_store_short v41, v9, s[92:95], s12 offen
    buffer_store_short v40, v8, s[92:95], s12 offen
    buffer_store_short_d16_hi v40, v8, s[92:95], s12 offen offset:8
    s_branch L_FIN
R_WQ:
    v_add_u32 v50, s12, v10
    v_add_u32 v51, s12, v11
    v_mov_b32 v36, 0
    v_mov_b32_e64 v37, 0
    v_mov_b32 v38, 0x3f803f80
R_WQ2:
    ds_read_b128 v[84:87], v50 offset:0
    ds_read_b128 v[88:91], v50 offset:64
    ds_read_b128 v[92:95], v50 offset:128
    s_cmp_eq_u32 s13, 0
    s_cbranch_scc1 WQ_B
    ds_read_b128 v[96:99], v50 offset:192
    ds_read_b128 v[20:23], v50 offset:256
    ds_read_b128 v[24:27], v50 offset:320
    ds_read_b128 v[28:31], v50 offset:384
    ds_read2st64_b32 v[52:53], v51 offset0:0 offset1:1
    ds_read2st64_b32 v[54:55], v51 offset0:2 offset1:3
    ds_read_b32 v56, v51 offset:1024
    s_waitcnt lgkmcnt(9)
    v_mfma_f32_16x16x32_bf16 v[68:71], v[84:87], a[0:3], 0
    v_mfma_f32_16x16x32_bf16 v[72:75], v[84:87], a[4:7], 0
    ds_read_b128 v[32:35], v50 offset:448
    s_waitcnt lgkmcnt(9)
    v_mfma_f32_16x16x32_bf16 v[68:71], v[88:91], a[8:11], v[68:71]
    v_mfma_f32_16x16x32_bf16 v[72:75], v[88:91], a[12:15], v[72:75]
    ds_read_b128 v[84:87], v50 offset:512
    s_waitcnt lgkmcnt(9)
    v_mfma_f32_16x16x32_bf16 v[68:71], v[92:95], a[16:19], v[68:71]
    v_mfma_f32_16x16x32_bf16 v[72:75], v[92:95], a[20:23], v[72:75]
    ds_read_b128 v[88:91], v50 offset:576
    s_waitcnt lgkmcnt(9)
    v_mfma_f32_16x16x32_bf16 v[68:71], v[96:99], a[24:27], v[68:71]
    s_waitcnt lgkmcnt(3)
    v_dot2c_f32_bf16 v36, v52, v52
    v_mfma_f32_16x16x32_bf16 v[72:75], v[96:99], a[28:31], v[72:75]
    ds_read_b128 v[92:95], v50 offset:640
    v_dot2c_f32_bf16 v37, v52, v38
    v_mfma_f32_16x16x32_bf16 v[68:71], v[20:23], a[32:35], v[68:71]
    v_dot2c_f32_bf16 v36, v53, v53
    v_mfma_f32_16x16x32_bf16 v[72:75], v[20:23], a[36:39], v[72:75]
    ds_read_b128 v[96:99], v50 offset:704
    v_dot2c_f32_bf16 v37, v53, v38
    v_mfma_f32_16x16x32_bf16 v[68:71], v[24:27], a[40:43], v[68:71]
    v_dot2c_f32_bf16 v36, v54, v54
    v_mfma_f32_16x16x32_bf16 v[72:75], v[24:27], a[44:47], v[72:75]
    ds_read_b128 v[20:23], v50 offset:768
    v_dot2c_f32_bf16 v37, v54, v38
    s_waitcnt lgkmcnt(5)
    v_mfma_f32_16x16x32_bf16 v[68:71], v[28:31], a[48:51], v[68:71]
    v_dot2c_f32_bf16 v36, v55, v55
    v_mfma_f32_16x16x32_bf16 v[72:75], v[28:31], a[52:55], v[72:75]
    ds_read_b128 v[24:27], v50 offset:832
    v_dot2c_f32_bf16 v37, v55, v38
    v_mfma_f32_16x16x32_bf16 v[68:71], v[32:35], a[56:59], v[68:71]
    v_dot2c_f32_bf16 v36, v56, v56
    v_mfma_f32_16x16x32_bf16 v[72:75], v[32:35], a[60:63], v[72:75]
    ds_read_b128 v[28:31], v50 offset:896
    v_dot2c_f32_bf16 v37, v56, v38
    s_waitcnt lgkmcnt(5)
    v_mfma_f32_16x16x32_bf16 v[68:71], v[84:87], a[64:67], v[68:71]
    s_nop 0
    v_permlane32_swap_b32_e64 v36, v37
    v_mfma_f32_16x16x32_bf16 v[72:75], v[84:87], a[68:71], v[72:75]
    ds_read_b128 v[32:35], v50 offset:960
    v_add_f32_e64 v36, v36, v37
    v_mfma_f32_16x16x32_bf16 v[68:71], v[88:91], a[72:75], v[68:71]
    v_mov_b32_e64 v37, v36
    v_mfma_f32_16x16x32_bf16 v[72:75], v[88:91], a[76:79], v[72:75]
    ds_read_b128 v[84:87], v50 offset:1024
    v_permlane16_swap_b32 v36, v37
    s_waitcnt lgkmcnt(5)
    v_mfma_f32_16x16x32_bf16 v[68:71], v[92:95], a[80:83], v[68:71]
    v_add_f32_e64 v36, v36, v37
    v_mfma_f32_16x16x32_bf16 v[72:75], v[92:95], a[84:87], v[72:75]
    ds_read_b128 v[88:91], v50 offset:1088
    v_add_f32_dpp v36, v36, v36 quad_perm:[1,0,3,2] row_mask:0xf bank_mask:0xf
    v_mfma_f32_16x16x32_bf16 v[68:71], v[96:99], a[88:91], v[68:71]
    v_nop_e64
    v_add_f32_dpp v36, v36, v36 quad_perm:[2,3,0,1] row_mask:0xf bank_mask:0xf
    v_mfma_f32_16x16x32_bf16 v[72:75], v[96:99], a[92:95], v[72:75]
    ds_read_b128 v[92:95], v50 offset:1152
    v_add_f32_dpp v36, v36, v36 row_half_mirror row_mask:0xf bank_mask:0xf
    s_waitcnt lgkmcnt(5)
    s_nop 0
    v_mfma_f32_16x16x32_bf16 v[68:71], v[20:23], a[96:99], v[68:71]
    v_add_f32_dpp v36, v36, v36 row_mirror row_mask:0xf bank_mask:0xf
    v_mfma_f32_16x16x32_bf16 v[72:75], v[20:23], a[100:103], v[72:75]
    ds_read_b128 v[96:99], v50 offset:1216
    v_mul_f32 v36, 0x3acccccd, v36
    v_mfma_f32_16x16x32_bf16 v[68:71], v[24:27], a[104:107], v[68:71]
    v_mov_b32 v37, v36
    s_nop 1
    v_permlane32_swap_b32_e64 v36, v37
    v_mfma_f32_16x16x32_bf16 v[72:75], v[24:27], a[108:111], v[72:75]
    v_fma_f32 v36, -v37, v37, v36
    v_max_f32 v36, 0, v36
    s_waitcnt lgkmcnt(4)
    v_mfma_f32_16x16x32_bf16 v[68:71], v[28:31], a[112:115], v[68:71]
    v_cvt_pk_bf16_f32 v36, v37, v36
    v_lshlrev_b32_e64 v37, 16, v36
    v_mfma_f32_16x16x32_bf16 v[72:75], v[28:31], a[116:119], v[72:75]
    v_and_b32 v36, 0xffff0000, v36
    v_add_f32 v36, 0x3727c5ac, v36
    v_mfma_f32_16x16x32_bf16 v[68:71], v[32:35], a[120:123], v[68:71]
    v_cvt_pk_bf16_f32 v36, v36, v36
    v_and_b32 v36, 0xffff0000, v36
    v_mfma_f32_16x16x32_bf16 v[72:75], v[32:35], a[124:127], v[72:75]
    v_sqrt_f32 v36, v36
    v_nop_e64
    v_cvt_pk_bf16_f32 v36, v36, v36
    s_waitcnt lgkmcnt(2)
    v_mfma_f32_16x16x32_bf16 v[68:71], v[84:87], a[128:131], v[68:71]
    v_and_b32 v36, 0xffff0000, v36
    v_rcp_f32_e64 v36, v36
    v_mfma_f32_16x16x32_bf16 v[72:75], v[84:87], a[132:135], v[72:75]
    v_mul_f32 v37, v37, v36
    v_mul_f32 v52, v37, v12
    v_mfma_f32_16x16x32_bf16 v[68:71], v[88:91], a[136:139], v[68:71]
    v_mul_f32_e64 v53, v37, v13
    v_mfma_f32_16x16x32_bf16 v[72:75], v[88:91], a[140:143], v[72:75]
    s_waitcnt lgkmcnt(0)
    v_mfma_f32_16x16x32_bf16 v[68:71], v[92:95], a[144:147], v[68:71]
    v_mfma_f32_16x16x32_bf16 v[72:75], v[92:95], a[148:151], v[72:75]
    v_mfma_f32_16x16x32_bf16 v[68:71], v[96:99], a[152:155], v[68:71]
    v_mfma_f32_16x16x32_bf16 v[72:75], v[96:99], a[156:159], v[72:75]
    s_cmp_eq_u32 s14, 1
    s_cbranch_scc1 WQC_32
    s_mov_b64 exec, 0xffff
    s_cmp_eq_u32 s79, 0
    s_nop 1
    s_nop 0
    v_fma_f32 v68, v68, v36, -v52
    v_fma_f32 v72, v72, v36, -v53
    v_cvt_pk_bf16_f32 v68, v68, v72
    v_min_u32 v68, -2, v68
    s_cbranch_scc1 QLOC_33
    buffer_store_dword v68, v11, s[80:83], s11 offen
    s_mov_b64 exec, -1
    s_setpc_b64 s[100:101]
QLOC_33:
    buffer_store_dword v68, v11, s[80:83], s11 offen sc1
    s_mov_b64 exec, -1
    s_setpc_b64 s[100:101]
WQC_32:
    s_nop 7
    v_mov_b32 v12, v68
    v_mov_b32_e64 v13, v72
    s_nop 0
    s_setpc_b64 s[100:101]
WQ_B:
    ds_read_b128 v[96:99], v50 offset:192
    ds_read_b128 v[20:23], v50 offset:256
    ds_read_b128 v[24:27], v50 offset:320
    ds_read_b128 v[28:31], v50 offset:384
    ds_read2st64_b32 v[52:53], v51 offset0:0 offset1:1
    ds_read2st64_b32 v[54:55], v51 offset0:2 offset1:3
    ds_read_b32 v56, v51 offset:1024
    s_waitcnt lgkmcnt(9)
    v_mfma_f32_16x16x32_bf16 v[68:71], v[84:87], a[160:163], 0
    v_mfma_f32_16x16x32_bf16 v[72:75], v[84:87], a[164:167], 0
    ds_read_b128 v[32:35], v50 offset:448
    s_waitcnt lgkmcnt(9)
    v_mfma_f32_16x16x32_bf16 v[68:71], v[88:91], a[168:171], v[68:71]
    v_mfma_f32_16x16x32_bf16 v[72:75], v[88:91], a[172:175], v[72:75]
    ds_read_b128 v[84:87], v50 offset:512
    s_waitcnt lgkmcnt(9)
    v_mfma_f32_16x16x32_bf16 v[68:71], v[92:95], a[176:179], v[68:71]
    v_mfma_f32_16x16x32_bf16 v[72:75], v[92:95], a[180:183], v[72:75]
    ds_read_b128 v[88:91], v50 offset:576
    s_waitcnt lgkmcnt(9)
    v_mfma_f32_16x16x32_bf16 v[68:71], v[96:99], a[184:187], v[68:71]
    s_waitcnt lgkmcnt(3)
    v_dot2c_f32_bf16 v36, v52, v52
    v_mfma_f32_16x16x32_bf16 v[72:75], v[96:99], a[188:191], v[72:75]
    ds_read_b128 v[92:95], v50 offset:640
    v_dot2c_f32_bf16 v37, v52, v38
    v_mfma_f32_16x16x32_bf16 v[68:71], v[20:23], a[192:195], v[68:71]
    v_dot2c_f32_bf16 v36, v53, v53
    v_mfma_f32_16x16x32_bf16 v[72:75], v[20:23], a[196:199], v[72:75]
    ds_read_b128 v[96:99], v50 offset:704
    v_dot2c_f32_bf16 v37, v53, v38
    v_mfma_f32_16x16x32_bf16 v[68:71], v[24:27], a[200:203], v[68:71]
    v_dot2c_f32_bf16 v36, v54, v54
    v_mfma_f32_16x16x32_bf16 v[72:75], v[24:27], a[204:207], v[72:75]
    ds_read_b128 v[20:23], v50 offset:768
    v_dot2c_f32_bf16 v37, v54, v38
    s_waitcnt lgkmcnt(5)
    v_mfma_f32_16x16x32_bf16 v[68:71], v[28:31], a[208:211], v[68:71]
    v_dot2c_f32_bf16 v36, v55, v55
    v_mfma_f32_16x16x32_bf16 v[72:75], v[28:31], a[212:215], v[72:75]
    ds_read_b128 v[24:27], v50 offset:832
    v_dot2c_f32_bf16 v37, v55, v38
    v_mfma_f32_16x16x32_bf16 v[68:71], v[32:35], a[216:219], v[68:71]
    v_dot2c_f32_bf16 v36, v56, v56
    v_mfma_f32_16x16x32_bf16 v[72:75], v[32:35], a[220:223], v[72:75]
    ds_read_b128 v[28:31], v50 offset:896
    v_dot2c_f32_bf16 v37, v56, v38
    s_waitcnt lgkmcnt(5)
    v_mfma_f32_16x16x32_bf16 v[68:71], v[84:87], a[224:227], v[68:71]
    s_nop 0
    v_permlane32_swap_b32_e64 v36, v37
    v_mfma_f32_16x16x32_bf16 v[72:75], v[84:87], a[228:231], v[72:75]
    ds_read_b128 v[32:35], v50 offset:960
    v_add_f32_e64 v36, v36, v37
    v_mfma_f32_16x16x32_bf16 v[68:71], v[88:91], a[232:235], v[68:71]
    v_mov_b32_e64 v37, v36
    v_mfma_f32_16x16x32_bf16 v[72:75], v[88:91], a[236:239], v[72:75]
    ds_read_b128 v[84:87], v50 offset:1024
    v_permlane16_swap_b32 v36, v37
    s_waitcnt lgkmcnt(5)
    v_mfma_f32_16x16x32_bf16 v[68:71], v[92:95], a[240:243], v[68:71]
    v_add_f32_e64 v36, v36, v37
    v_mfma_f32_16x16x32_bf16 v[72:75], v[92:95], a[244:247], v[72:75]
    ds_read_b128 v[88:91], v50 offset:1088
    v_add_f32_dpp v36, v36, v36 quad_perm:[1,0,3,2] row_mask:0xf bank_mask:0xf
    v_mfma_f32_16x16x32_bf16 v[68:71], v[96:99], a[248:251], v[68:71]
    v_nop_e64
    v_add_f32_dpp v36, v36, v36 quad_perm:[2,3,0,1] row_mask:0xf bank_mask:0xf
    v_mfma_f32_16x16x32_bf16 v[72:75], v[96:99], a[252:255], v[72:75]
    ds_read_b128 v[92:95], v50 offset:1152
    v_add_f32_dpp v36, v36, v36 row_half_mirror row_mask:0xf bank_mask:0xf
    s_waitcnt lgkmcnt(5)
    s_nop 0
    v_mfma_f32_16x16x32_bf16 v[68:71], v[20:23], v[192:195], v[68:71]
    v_add_f32_dpp v36, v36, v36 row_mirror row_mask:0xf bank_mask:0xf
    v_mfma_f32_16x16x32_bf16 v[72:75], v[20:23], v[196:199], v[72:75]
    ds_read_b128 v[96:99], v50 offset:1216
    v_mul_f32 v36, 0x3acccccd, v36
    v_mfma_f32_16x16x32_bf16 v[68:71], v[24:27], v[200:203], v[68:71]
    v_mov_b32 v37, v36
    s_nop 1
    v_permlane32_swap_b32_e64 v36, v37
    v_mfma_f32_16x16x32_bf16 v[72:75], v[24:27], v[204:207], v[72:75]
    v_fma_f32 v36, -v37, v37, v36
    v_max_f32 v36, 0, v36
    s_waitcnt lgkmcnt(4)
    v_mfma_f32_16x16x32_bf16 v[68:71], v[28:31], v[208:211], v[68:71]
    v_cvt_pk_bf16_f32 v36, v37, v36
    v_lshlrev_b32_e64 v37, 16, v36
    v_mfma_f32_16x16x32_bf16 v[72:75], v[28:31], v[212:215], v[72:75]
    v_and_b32 v36, 0xffff0000, v36
    v_add_f32 v36, 0x3727c5ac, v36
    v_mfma_f32_16x16x32_bf16 v[68:71], v[32:35], v[216:219], v[68:71]
    v_cvt_pk_bf16_f32 v36, v36, v36
    v_and_b32 v36, 0xffff0000, v36
    v_mfma_f32_16x16x32_bf16 v[72:75], v[32:35], v[220:223], v[72:75]
    v_sqrt_f32 v36, v36
    v_nop_e64
    v_cvt_pk_bf16_f32 v36, v36, v36
    s_waitcnt lgkmcnt(2)
    v_mfma_f32_16x16x32_bf16 v[68:71], v[84:87], v[224:227], v[68:71]
    v_and_b32 v36, 0xffff0000, v36
    v_rcp_f32_e64 v36, v36
    v_mfma_f32_16x16x32_bf16 v[72:75], v[84:87], v[228:231], v[72:75]
    v_mul_f32 v37, v37, v36
    v_mul_f32 v52, v37, v14
    v_mfma_f32_16x16x32_bf16 v[68:71], v[88:91], v[232:235], v[68:71]
    v_mul_f32_e64 v53, v37, v15
    v_mfma_f32_16x16x32_bf16 v[72:75], v[88:91], v[236:239], v[72:75]
    s_waitcnt lgkmcnt(0)
    v_mfma_f32_16x16x32_bf16 v[68:71], v[92:95], v[240:243], v[68:71]
    v_mfma_f32_16x16x32_bf16 v[72:75], v[92:95], v[244:247], v[72:75]
    v_mfma_f32_16x16x32_bf16 v[68:71], v[96:99], v[248:251], v[68:71]
    v_mfma_f32_16x16x32_bf16 v[72:75], v[96:99], v[252:255], v[72:75]
    s_cmp_eq_u32 s14, 1
    s_cbranch_scc1 WQC_34
    s_mov_b64 exec, 0xffff
    s_cmp_eq_u32 s79, 0
    s_nop 1
    s_nop 0
    v_fma_f32 v68, v68, v36, -v52
    v_fma_f32 v72, v72, v36, -v53
    v_cvt_pk_bf16_f32 v68, v68, v72
    v_min_u32 v68, -2, v68
    s_cbranch_scc1 QLOC_35
    buffer_store_dword v68, v11, s[80:83], s11 offen
    s_mov_b64 exec, -1
    s_setpc_b64 s[100:101]
QLOC_35:
    buffer_store_dword v68, v11, s[80:83], s11 offen sc1
    s_mov_b64 exec, -1
    s_setpc_b64 s[100:101]
WQC_34:
    s_nop 7
    v_mov_b32 v14, v68
    v_mov_b32 v15, v72
    s_nop 0
    s_setpc_b64 s[100:101]
L_FIN:
L_END:
    s_endpgm
.section .rodata,"a"
.p2align 6
.amdhsa_kernel interleave_layers__gqa_block_cached__gqa_block_cached__decode_kernel
  .amdhsa_next_free_vgpr 512
  .amdhsa_next_free_sgpr 102
  .amdhsa_accum_offset 256
  .amdhsa_group_segment_fixed_size 0
  .amdhsa_kernarg_size 104
  .amdhsa_user_sgpr_count 2
  .amdhsa_user_sgpr_kernarg_segment_ptr 1
  .amdhsa_system_sgpr_workgroup_id_x 1
  .amdhsa_float_denorm_mode_32 3
.end_amdhsa_kernel
```
